```python
import torch

def _softmax(x, axis=-1):
    return torch.softmax(x, dim=axis)
def _gelu(x):
    return torch.nn.functional.gelu(x, approximate="tanh")
def _silu(x):
    return torch.nn.functional.silu(x)
def _sigmoid(x):
    return torch.sigmoid(x)
def _layernorm(x, axis=-1, eps=1e-5):
    m = x.mean(dim=axis, keepdim=True)
    v = x.var(dim=axis, keepdim=True, unbiased=False)
    return (x - m) / torch.sqrt(v + eps)
def _scatter_add(tgt, idx, src, axis=0):
    return tgt.clone().index_add_(axis, idx, src)
def _segment_sum(src, seg, n):
    out = torch.zeros((n,) + src.shape[1:], dtype=src.dtype)
    return out.index_add_(0, seg, src)
def _pad(x, pw):
    flat = tuple(v for pair in reversed(pw) for v in pair)
    return torch.nn.functional.pad(x, flat)

kernel_name = 'sequential_preLN__spectral_gfnet__glu_gated_glu__prompt'

def setup_inputs():

    _w = (lambda a: (lambda t: t.to(torch.bfloat16) if t.is_floating_point() else t)(torch.as_tensor(a)))
    def _A_setup():
        B, S, D = 1, 2048, 448
        Df = D // 2 + 1
        return {
            "x": _w((lambda *s: torch.randn(*s, dtype=torch.bfloat16) * 0.05)(B, S, D)),
            "w_r": _w((lambda *s: torch.randn(*s, dtype=torch.bfloat16) * 0.4)(S, Df) * 0.02),
            "w_i": _w((lambda *s: torch.randn(*s, dtype=torch.bfloat16) * 0.4)(S, Df) * 0.02),
        }
    _A_in = _A_setup()

    def _B_setup():
        B, S, D, F = 1, 2048, 448, 1792
        return {
            "x": _w((lambda *s: torch.randn(*s, dtype=torch.bfloat16) * 0.05)(B, S, D)),
            "w_gate": _w((lambda *s: torch.randn(*s, dtype=torch.bfloat16) * 0.05)(D, F)),
            "w_up": _w((lambda *s: torch.randn(*s, dtype=torch.bfloat16) * 0.05)(D, F)),
            "w_down": _w((lambda *s: torch.randn(*s, dtype=torch.bfloat16) * 0.05)(F, D)),
        }
    _B_in = _B_setup()

    return {
        "A_x": _A_in["x"],
        "A_w_r": _A_in["w_r"],
        "A_w_i": _A_in["w_i"],
        "B_x": _B_in["x"],
        "B_w_gate": _B_in["w_gate"],
        "B_w_up": _B_in["w_up"],
        "B_w_down": _B_in["w_down"],
    }

def reference(A_x, A_w_r, A_w_i, B_x, B_w_gate, B_w_up, B_w_down):
    def _A_ref(x, w_r, w_i):
        B, S, D = x.shape
        X = (lambda x, axes=(-2,-1): torch.fft.rfft2(x.float(), dim=axes))(x, axes=(-2, -1))
        W = w_r + 1j * w_i
        X = X * W
        y = (lambda x, s, axes=(-2,-1): torch.fft.irfft2(x, s=s, dim=axes).to(torch.bfloat16))(X, (S, D), axes=(-2, -1))
        return y

    def _B_ref(x, w_gate, w_up, w_down):
        g = torch.einsum("bsd,df->bsf", x, w_gate)
        u = torch.einsum("bsd,df->bsf", x, w_up)
        h = _sigmoid(g) * u
        return torch.einsum("bsf,fd->bsd", h, w_down)

    x = A_x
    h = x + _A_ref(_layernorm(x, axis=-1), A_w_r, A_w_i)
    h2 = h + _B_ref(_layernorm(h, axis=-1), B_w_gate, B_w_up, B_w_down)
    return h2
```

```asm
; @launch grid=(256,1,1) block=(256,1,1) lds=157696
.amdgcn_target "amdgcn-amd-amdhsa--gfx950"
.text
.globl sequential_preLN__spectral_gfnet__glu_gated_glu__prompt_kernel
.p2align 8
.type sequential_preLN__spectral_gfnet__glu_gated_glu__prompt_kernel,@function
sequential_preLN__spectral_gfnet__glu_gated_glu__prompt_kernel:
    s_cmp_ge_u32 s2, 256
    s_cbranch_scc1 K_END
    s_load_dwordx2 s[4:5], s[0:1], 0
    s_load_dwordx4 s[96:99], s[0:1], 32
    s_load_dwordx2 s[88:89], s[0:1], 48
    s_load_dwordx4 s[60:63], s[0:1], 64
    s_load_dwordx4 s[92:95], s[0:1], 8
    v_and_b32_e64 v1, 63, v0
    v_lshrrev_b32 v4, 6, v0
    s_nop 0
    v_readfirstlane_b32 s3, v4
    s_getpc_b64 s[48:49]
KW_PC:
    s_sub_u32 s48, s48, KW_PC-sequential_preLN__spectral_gfnet__glu_gated_glu__prompt_kernel
    s_subb_u32 s49, s49, 0
    s_mov_b32 s50, K_END2-sequential_preLN__spectral_gfnet__glu_gated_glu__prompt_kernel
    s_mov_b32 s51, 0x00020000
    s_lshr_b32 s54, s2, 3
    s_lshl_b32 s54, s54, 2
    s_add_u32 s54, s54, s3
    s_mul_i32 s54, s54, 640
    s_cmp_lt_u32 s2, 128
    s_cselect_b32 s54, s54, 0x40000000
    v_lshlrev_b32 v4, 7, v1
    v_cmp_gt_u32 vcc, 5, v1
    v_mov_b32 v5, 0x40000000
    s_nop 0
    v_cndmask_b32 v4, v5, v4, vcc
    buffer_load_dword v2, v4, s[48:51], s54 offen
    v_and_b32 v8, 15, v1
    v_lshrrev_b32 v9, 4, v1
    v_and_b32 v10, 31, v1
    v_lshrrev_b32 v11, 5, v1
    v_lshlrev_b32 v12, 4, v1
    s_and_b32 s52, s2, 63
    s_lshr_b32 s53, s2, 6
    s_lshl_b32 s53, s53, 2
    s_add_u32 s53, s53, s3
    s_mov_b32 s90, 0x41800000
    s_mov_b32 s91, 0xc4600000
    v_cvt_f32_u32 v16, v9
    s_lshl_b32 s54, s3, 9
    s_add_u32 s54, s54, s52
    v_lshlrev_b32 v4, 6, v11
    v_add_u32 v4, s54, v4
    v_mul_u32_u24 v4, 896, v4
    v_lshlrev_b32 v5, 4, v10
    v_add_u32 v17, v4, v5
    v_sub_u32 v18, v4, v5
    v_add_u32 v18, 880, v18
    v_cmp_gt_u32 vcc, 28, v10
    v_mov_b32 v4, 0x40000000
    s_nop 0
    v_cndmask_b32 v17, v4, v17, vcc
    v_cndmask_b32 v18, v4, v18, vcc
    v_cndmask_b32 v19, 0, 1.0, vcc
    s_lshl_b32 s54, s53, 4
    v_add_u32 v141, s54, v8
    v_cvt_f32_u32 v140, v141
    v_mul_f32 v182, 0x3b124925, v140
    v_fma_f32 v181, v16, s90, 1.0
    v_mov_b32 v180, 0x42800000
    v_mul_f32 v180, v180, v140
    v_mul_f32 v177, 0x3a924925, v180
    v_floor_f32 v177, v177
    v_fma_f32 v180, v177, s91, v180
    v_mul_f32 v180, 0x3a924925, v180
    v_cos_f32 v180, v180
    v_add_f32 v176, 0x00000000, v181
    v_mul_f32 v176, v176, v140
    v_mul_f32 v177, 0x3a924925, v176
    v_floor_f32 v177, v177
    v_fma_f32 v176, v177, s91, v176
    v_mul_f32 v176, 0x3a924925, v176
    v_add_f32 v180, v180, v180
    v_mov_b32 v178, v176
    v_fma_f32 v179, v182, 1.0, v176
    v_cos_f32 v144, v178
    v_cos_f32 v145, v179
    v_sin_f32 v160, v178
    v_sin_f32 v161, v179
    v_fma_f32 v178, v182, 2.0, v176
    v_mov_b32 v179, 0x40400000
    v_fma_f32 v179, v182, v179, v176
    v_cos_f32 v146, v178
    v_cos_f32 v147, v179
    v_sin_f32 v162, v178
    v_sin_f32 v163, v179
    v_fma_f32 v178, v182, 4.0, v176
    v_mov_b32 v179, 0x40a00000
    v_fma_f32 v179, v182, v179, v176
    v_cos_f32 v148, v178
    v_cos_f32 v149, v179
    v_sin_f32 v164, v178
    v_sin_f32 v165, v179
    v_mov_b32 v178, 0x40c00000
    v_fma_f32 v178, v182, v178, v176
    v_mov_b32 v179, 0x40e00000
    v_fma_f32 v179, v182, v179, v176
    v_cos_f32 v150, v178
    v_cos_f32 v151, v179
    v_sin_f32 v166, v178
    v_sin_f32 v167, v179
    v_cvt_pk_bf16_f32 v60, v144, v145
    v_cvt_pk_bf16_f32 v88, -v160, -v161
    v_cvt_pk_bf16_f32 v61, v146, v147
    v_cvt_pk_bf16_f32 v89, -v162, -v163
    v_cvt_pk_bf16_f32 v62, v148, v149
    v_cvt_pk_bf16_f32 v90, -v164, -v165
    v_cvt_pk_bf16_f32 v63, v150, v151
    v_cvt_pk_bf16_f32 v91, -v166, -v167
    v_add_f32 v176, 0x42800000, v181
    v_mul_f32 v176, v176, v140
    v_mul_f32 v177, 0x3a924925, v176
    v_floor_f32 v177, v177
    v_fma_f32 v176, v177, s91, v176
    v_mul_f32 v176, 0x3a924925, v176
    v_mov_b32 v178, v176
    v_fma_f32 v179, v182, 1.0, v176
    s_waitcnt lgkmcnt(0)
    s_mov_b32 s6, s62
    s_mov_b32 s7, s63
    s_mov_b32 s12, s6
    s_mov_b32 s13, s7
    s_mov_b32 s14, 0x400000
    s_mov_b32 s15, 0x00020000
    s_add_u32 s56, s6, 0x1600000
    s_addc_u32 s57, s7, 0
    s_mov_b32 s58, 0x28000
    s_mov_b32 s59, 0x00020000
    s_mov_b32 s8, s4
    s_mov_b32 s9, s5
    s_mov_b32 s10, 0x1c0000
    s_mov_b32 s11, 0x00020000
    s_mov_b32 s54, 0
    buffer_load_dwordx4 v[24:27], v17, s[8:11], s54 offen
    buffer_load_dwordx4 v[28:31], v18, s[8:11], s54 offen
    s_mov_b32 s54, 114688
    buffer_load_dwordx4 v[32:35], v17, s[8:11], s54 offen
    buffer_load_dwordx4 v[36:39], v18, s[8:11], s54 offen
    s_mov_b32 s54, 229376
    buffer_load_dwordx4 v[40:43], v17, s[8:11], s54 offen
    buffer_load_dwordx4 v[44:47], v18, s[8:11], s54 offen
    s_mov_b32 s54, 344064
    buffer_load_dwordx4 v[48:51], v17, s[8:11], s54 offen
    buffer_load_dwordx4 v[52:55], v18, s[8:11], s54 offen
    v_lshlrev_b32 v4, 15, v0
    s_lshl_b32 s54, s2, 7
    v_mov_b32 v5, 0
    buffer_store_dword v5, v4, s[56:59], s54 offen sc0 sc1
    s_mov_b32 s16, s60
    s_mov_b32 s17, s61
    s_mov_b32 s18, 0x100
    s_mov_b32 s19, 0x00020000
    s_mov_b32 s36, s96
    s_mov_b32 s37, s97
    s_mov_b32 s38, 0x188000
    s_mov_b32 s39, 0x00020000
    s_mov_b32 s40, s98
    s_mov_b32 s41, s99
    s_mov_b32 s42, 0x188000
    s_mov_b32 s43, 0x00020000
    s_mov_b32 s24, s88
    s_mov_b32 s25, s89
    s_mov_b32 s26, 0x188000
    s_mov_b32 s27, 0x00020000
    s_add_u32 s44, s6, 0xa00000
    s_addc_u32 s45, s7, 0
    s_mov_b32 s46, 0x188000
    s_mov_b32 s47, 0x00020000
    s_mov_b32 s28, s92
    s_mov_b32 s29, s93
    s_mov_b32 s30, 0xe1000
    s_mov_b32 s31, 0x00020000
    s_mov_b32 s32, s94
    s_mov_b32 s33, s95
    s_mov_b32 s34, 0xe1000
    s_mov_b32 s35, 0x00020000
    s_and_b32 s60, s2, 7
    s_lshr_b32 s61, s2, 3
    s_lshr_b32 s4, s60, 1
    s_lshl_b32 s4, s4, 2
    s_and_b32 s63, s61, 3
    s_add_u32 s4, s4, s63
    s_and_b32 s5, s60, 1
    s_mul_i32 s5, s5, 7
    s_lshr_b32 s63, s61, 2
    s_add_u32 s5, s5, s63
    s_lshr_b32 s61, s2, 3
    s_and_b32 s61, s61, 3
    s_lshl_b32 s61, s61, 2
    s_add_u32 s61, s61, s3
    s_mul_i32 s61, s61, 100352
    s_lshl_b32 s62, s5, 8
    s_add_u32 s61, s61, s62
    s_cmp_ge_u32 s2, 224
    s_cselect_b32 s61, 0x40000000, s61
    v_lshrrev_b32 v4, 1, v1
    v_mul_u32_u24 v4, 3584, v4
    v_and_b32 v5, 1, v1
    v_lshl_add_u32 v4, v5, 7, v4
    v_add_u32 v4, s61, v4
    v_cmp_gt_u32 vcc, 56, v1
    v_mov_b32 v5, 0x40000000
    s_nop 0
    v_cndmask_b32 v57, v5, v4, vcc
    buffer_load_dword v2, v57, s[36:39], 0 offen
    buffer_load_dword v3, v57, s[40:43], 0 offen
    v_cos_f32 v152, v178
    v_cos_f32 v153, v179
    v_sin_f32 v168, v178
    v_sin_f32 v169, v179
    v_fma_f32 v178, v182, 2.0, v176
    v_mov_b32 v179, 0x40400000
    v_fma_f32 v179, v182, v179, v176
    v_cos_f32 v154, v178
    v_cos_f32 v155, v179
    v_sin_f32 v170, v178
    v_sin_f32 v171, v179
    v_fma_f32 v178, v182, 4.0, v176
    v_mov_b32 v179, 0x40a00000
    v_fma_f32 v179, v182, v179, v176
    v_cos_f32 v156, v178
    v_cos_f32 v157, v179
    v_sin_f32 v172, v178
    v_sin_f32 v173, v179
    v_mov_b32 v178, 0x40c00000
    v_fma_f32 v178, v182, v178, v176
    v_mov_b32 v179, 0x40e00000
    v_fma_f32 v179, v182, v179, v176
    v_cos_f32 v158, v178
    v_cos_f32 v159, v179
    v_sin_f32 v174, v178
    v_sin_f32 v175, v179
    v_cvt_pk_bf16_f32 v64, v152, v153
    v_cvt_pk_bf16_f32 v92, -v168, -v169
    v_cvt_pk_bf16_f32 v65, v154, v155
    v_cvt_pk_bf16_f32 v93, -v170, -v171
    v_cvt_pk_bf16_f32 v66, v156, v157
    v_cvt_pk_bf16_f32 v94, -v172, -v173
    v_cvt_pk_bf16_f32 v67, v158, v159
    v_cvt_pk_bf16_f32 v95, -v174, -v175
    v_fma_f32 v144, v180, v152, -v144
    v_fma_f32 v160, v180, v168, -v160
    v_fma_f32 v145, v180, v153, -v145
    v_fma_f32 v161, v180, v169, -v161
    v_fma_f32 v146, v180, v154, -v146
    v_fma_f32 v162, v180, v170, -v162
    v_fma_f32 v147, v180, v155, -v147
    v_fma_f32 v163, v180, v171, -v163
    v_fma_f32 v148, v180, v156, -v148
    v_fma_f32 v164, v180, v172, -v164
    v_fma_f32 v149, v180, v157, -v149
    v_fma_f32 v165, v180, v173, -v165
    v_fma_f32 v150, v180, v158, -v150
    v_fma_f32 v166, v180, v174, -v166
    v_fma_f32 v151, v180, v159, -v151
    v_fma_f32 v167, v180, v175, -v167
    v_cvt_pk_bf16_f32 v68, v144, v145
    v_cvt_pk_bf16_f32 v96, -v160, -v161
    v_cvt_pk_bf16_f32 v69, v146, v147
    v_cvt_pk_bf16_f32 v97, -v162, -v163
    v_cvt_pk_bf16_f32 v70, v148, v149
    v_cvt_pk_bf16_f32 v98, -v164, -v165
    v_cvt_pk_bf16_f32 v71, v150, v151
    v_cvt_pk_bf16_f32 v99, -v166, -v167
    v_fma_f32 v152, v180, v144, -v152
    v_fma_f32 v168, v180, v160, -v168
    v_fma_f32 v153, v180, v145, -v153
    v_fma_f32 v169, v180, v161, -v169
    v_fma_f32 v154, v180, v146, -v154
    v_fma_f32 v170, v180, v162, -v170
    v_fma_f32 v155, v180, v147, -v155
    v_fma_f32 v171, v180, v163, -v171
    v_fma_f32 v156, v180, v148, -v156
    v_fma_f32 v172, v180, v164, -v172
    v_fma_f32 v157, v180, v149, -v157
    v_fma_f32 v173, v180, v165, -v173
    v_fma_f32 v158, v180, v150, -v158
    v_fma_f32 v174, v180, v166, -v174
    v_fma_f32 v159, v180, v151, -v159
    v_fma_f32 v175, v180, v167, -v175
    v_cvt_pk_bf16_f32 v72, v152, v153
    v_cvt_pk_bf16_f32 v100, -v168, -v169
    v_cvt_pk_bf16_f32 v73, v154, v155
    v_cvt_pk_bf16_f32 v101, -v170, -v171
    v_cvt_pk_bf16_f32 v74, v156, v157
    v_cvt_pk_bf16_f32 v102, -v172, -v173
    v_cvt_pk_bf16_f32 v75, v158, v159
    v_cvt_pk_bf16_f32 v103, -v174, -v175
    v_fma_f32 v144, v180, v152, -v144
    v_fma_f32 v160, v180, v168, -v160
    v_fma_f32 v145, v180, v153, -v145
    v_fma_f32 v161, v180, v169, -v161
    v_fma_f32 v146, v180, v154, -v146
    v_fma_f32 v162, v180, v170, -v162
    v_fma_f32 v147, v180, v155, -v147
    v_fma_f32 v163, v180, v171, -v163
    v_fma_f32 v148, v180, v156, -v148
    v_fma_f32 v164, v180, v172, -v164
    v_fma_f32 v149, v180, v157, -v149
    v_fma_f32 v165, v180, v173, -v165
    v_fma_f32 v150, v180, v158, -v150
    v_fma_f32 v166, v180, v174, -v166
    v_fma_f32 v151, v180, v159, -v151
    v_fma_f32 v167, v180, v175, -v167
    v_cvt_pk_bf16_f32 v76, v144, v145
    v_cvt_pk_bf16_f32 v104, -v160, -v161
    v_cvt_pk_bf16_f32 v77, v146, v147
    v_cvt_pk_bf16_f32 v105, -v162, -v163
    v_cvt_pk_bf16_f32 v78, v148, v149
    v_cvt_pk_bf16_f32 v106, -v164, -v165
    v_cvt_pk_bf16_f32 v79, v150, v151
    v_cvt_pk_bf16_f32 v107, -v166, -v167
    v_fma_f32 v152, v180, v144, -v152
    v_fma_f32 v168, v180, v160, -v168
    v_fma_f32 v153, v180, v145, -v153
    v_fma_f32 v169, v180, v161, -v169
    v_fma_f32 v154, v180, v146, -v154
    v_fma_f32 v170, v180, v162, -v170
    v_fma_f32 v155, v180, v147, -v155
    v_fma_f32 v171, v180, v163, -v171
    v_fma_f32 v156, v180, v148, -v156
    v_fma_f32 v172, v180, v164, -v172
    v_fma_f32 v157, v180, v149, -v157
    v_fma_f32 v173, v180, v165, -v173
    v_fma_f32 v158, v180, v150, -v158
    v_fma_f32 v174, v180, v166, -v174
    v_fma_f32 v159, v180, v151, -v159
    v_fma_f32 v175, v180, v167, -v175
    v_cvt_pk_bf16_f32 v80, v152, v153
    v_cvt_pk_bf16_f32 v108, -v168, -v169
    v_cvt_pk_bf16_f32 v81, v154, v155
    v_cvt_pk_bf16_f32 v109, -v170, -v171
    v_cvt_pk_bf16_f32 v82, v156, v157
    v_cvt_pk_bf16_f32 v110, -v172, -v173
    v_cvt_pk_bf16_f32 v83, v158, v159
    v_cvt_pk_bf16_f32 v111, -v174, -v175
    v_fma_f32 v144, v180, v152, -v144
    v_fma_f32 v160, v180, v168, -v160
    v_fma_f32 v145, v180, v153, -v145
    v_fma_f32 v161, v180, v169, -v161
    v_fma_f32 v146, v180, v154, -v146
    v_fma_f32 v162, v180, v170, -v162
    v_fma_f32 v147, v180, v155, -v147
    v_fma_f32 v163, v180, v171, -v163
    v_fma_f32 v148, v180, v156, -v148
    v_fma_f32 v164, v180, v172, -v164
    v_fma_f32 v149, v180, v157, -v149
    v_fma_f32 v165, v180, v173, -v165
    v_fma_f32 v150, v180, v158, -v150
    v_fma_f32 v166, v180, v174, -v166
    v_fma_f32 v151, v180, v159, -v151
    v_fma_f32 v167, v180, v175, -v167
    v_cvt_pk_bf16_f32 v84, v144, v145
    v_cvt_pk_bf16_f32 v112, -v160, -v161
    v_cvt_pk_bf16_f32 v85, v146, v147
    v_cvt_pk_bf16_f32 v113, -v162, -v163
    v_cvt_pk_bf16_f32 v86, v148, v149
    v_cvt_pk_bf16_f32 v114, -v164, -v165
    v_cvt_pk_bf16_f32 v87, v150, v151
    v_cvt_pk_bf16_f32 v115, -v166, -v167
    v_lshlrev_b32 v4, 8, v9
    v_add_u32 v4, s52, v4
    v_cvt_f32_u32 v4, v4
    v_add_f32 v144, 0x00000000, v4
    v_mul_f32 v144, 0x3a000000, v144
    v_add_f32 v145, 0x42800000, v4
    v_mul_f32 v145, 0x3a000000, v145
    v_add_f32 v146, 0x43000000, v4
    v_mul_f32 v146, 0x3a000000, v146
    v_add_f32 v147, 0x43400000, v4
    v_mul_f32 v147, 0x3a000000, v147
    v_add_f32 v148, 0x44800000, v4
    v_mul_f32 v148, 0x3a000000, v148
    v_add_f32 v149, 0x44880000, v4
    v_mul_f32 v149, 0x3a000000, v149
    v_add_f32 v150, 0x44900000, v4
    v_mul_f32 v150, 0x3a000000, v150
    v_add_f32 v151, 0x44980000, v4
    v_mul_f32 v151, 0x3a000000, v151
    v_cvt_f32_u32 v152, v8
    v_mul_f32 v154, v152, v144
    v_mul_f32 v155, v152, v145
    v_fract_f32 v154, v154
    v_fract_f32 v155, v155
    v_cos_f32 v156, v154
    v_cos_f32 v157, v155
    v_sin_f32 v158, v154
    v_sin_f32 v159, v155
    v_cvt_pk_bf16_f32 v116, v156, v157
    v_cvt_pk_bf16_f32 v124, v158, v159
    v_cvt_pk_bf16_f32 v132, -v158, -v159
    v_mul_f32 v154, v152, v146
    v_mul_f32 v155, v152, v147
    v_fract_f32 v154, v154
    v_fract_f32 v155, v155
    v_cos_f32 v156, v154
    v_cos_f32 v157, v155
    v_sin_f32 v158, v154
    v_sin_f32 v159, v155
    v_cvt_pk_bf16_f32 v117, v156, v157
    v_cvt_pk_bf16_f32 v125, v158, v159
    v_cvt_pk_bf16_f32 v133, -v158, -v159
    v_mul_f32 v154, v152, v148
    v_mul_f32 v155, v152, v149
    v_fract_f32 v154, v154
    v_fract_f32 v155, v155
    v_cos_f32 v156, v154
    v_cos_f32 v157, v155
    v_sin_f32 v158, v154
    v_sin_f32 v159, v155
    v_cvt_pk_bf16_f32 v118, v156, v157
    v_cvt_pk_bf16_f32 v126, v158, v159
    v_cvt_pk_bf16_f32 v134, -v158, -v159
    v_mul_f32 v154, v152, v150
    v_mul_f32 v155, v152, v151
    v_fract_f32 v154, v154
    v_fract_f32 v155, v155
    v_cos_f32 v156, v154
    v_cos_f32 v157, v155
    v_sin_f32 v158, v154
    v_sin_f32 v159, v155
    v_cvt_pk_bf16_f32 v119, v156, v157
    v_cvt_pk_bf16_f32 v127, v158, v159
    v_cvt_pk_bf16_f32 v135, -v158, -v159
    v_cvt_f32_u32 v152, v8
    v_add_f32 v152, 0x41800000, v152
    v_mul_f32 v154, v152, v144
    v_mul_f32 v155, v152, v145
    v_fract_f32 v154, v154
    v_fract_f32 v155, v155
    v_cos_f32 v156, v154
    v_cos_f32 v157, v155
    v_sin_f32 v158, v154
    v_sin_f32 v159, v155
    v_cvt_pk_bf16_f32 v120, v156, v157
    v_cvt_pk_bf16_f32 v128, v158, v159
    v_cvt_pk_bf16_f32 v136, -v158, -v159
    v_mul_f32 v154, v152, v146
    v_mul_f32 v155, v152, v147
    v_fract_f32 v154, v154
    v_fract_f32 v155, v155
    v_cos_f32 v156, v154
    v_cos_f32 v157, v155
    v_sin_f32 v158, v154
    v_sin_f32 v159, v155
    v_cvt_pk_bf16_f32 v121, v156, v157
    v_cvt_pk_bf16_f32 v129, v158, v159
    v_cvt_pk_bf16_f32 v137, -v158, -v159
    v_mul_f32 v154, v152, v148
    v_mul_f32 v155, v152, v149
    v_fract_f32 v154, v154
    v_fract_f32 v155, v155
    v_cos_f32 v156, v154
    v_cos_f32 v157, v155
    v_sin_f32 v158, v154
    v_sin_f32 v159, v155
    v_cvt_pk_bf16_f32 v122, v156, v157
    v_cvt_pk_bf16_f32 v130, v158, v159
    v_cvt_pk_bf16_f32 v138, -v158, -v159
    v_mul_f32 v154, v152, v150
    v_mul_f32 v155, v152, v151
    v_fract_f32 v154, v154
    v_fract_f32 v155, v155
    v_cos_f32 v156, v154
    v_cos_f32 v157, v155
    v_sin_f32 v158, v154
    v_sin_f32 v159, v155
    v_cvt_pk_bf16_f32 v123, v156, v157
    v_cvt_pk_bf16_f32 v131, v158, v159
    v_cvt_pk_bf16_f32 v139, -v158, -v159
    s_lshl_b32 s63, s5, 2
    s_add_u32 s63, s63, s3
    s_lshl_b32 s63, s63, 6
    s_cmp_ge_u32 s2, 224
    s_cselect_b32 s63, 0x40000000, s63
    v_lshrrev_b32 v4, 2, v1
    v_and_b32 v5, 3, v1
    v_lshlrev_b32 v6, 4, v5
    v_mul_u32_u24 v20, 3584, v4
    v_add3_u32 v20, v20, v6, s63
    v_mul_u32_u24 v22, 896, v4
    v_add_u32 v22, v22, v6
    s_mul_i32 s88, s3, 30720
    s_add_u32 s88, s88, 34816
    v_bfe_u32 v21, v1, 2, 2
    v_lshlrev_b32 v21, 6, v21
    v_and_b32 v4, 1, v9
    v_lshl_add_u32 v21, v4, 5, v21
    v_lshl_add_u32 v21, v5, 3, v21
    v_add_u32 v21, s88, v21
    v_lshl_add_u32 v56, v11, 8, v21
    v_lshl_add_u32 v21, v11, 9, v21
    s_and_b32 s63, s2, 31
    s_and_b32 s61, s3, 1
    s_lshl_b32 s61, s61, 10
    s_add_u32 s63, s63, s61
    s_mul_i32 s63, s63, 450
    s_lshr_b32 s61, s2, 5
    s_lshl_b32 s61, s61, 6
    s_lshr_b32 s62, s3, 1
    s_lshl_b32 s62, s62, 5
    s_add_u32 s63, s63, s61
    s_add_u32 s63, s63, s62
    s_mov_b32 s61, 14400
    v_mul_lo_u32 v58, v10, s61
    v_mad_u32_u24 v58, v11, 30, v58
    v_add_u32 v58, s63, v58
    v_and_b32 v5, 3, v8
    v_lshlrev_b32 v142, 18, v9
    v_lshl_add_u32 v142, v5, 16, v142
    v_and_b32 v4, 0xfc, v141
    v_lshl_add_u32 v142, v4, 2, v142
    s_lshl_b32 s54, s52, 10
    v_add_u32 v142, s54, v142
    s_mov_b32 s54, 0x100000
    s_waitcnt vmcnt(3)
    s_waitcnt vmcnt(2)
    s_and_b32 s54, s2, 7
    s_lshl_b32 s54, s54, 5
    v_mov_b32 v13, 1
    v_lshlrev_b32 v14, 20, v0
    buffer_atomic_add v13, v14, s[16:19], s54 offen sc1
    buffer_load_ushort v2, v58, s[28:31], 0 offen
    buffer_load_ushort v3, v58, s[32:35], 0 offen
    v_lshlrev_b32 v224, 16, v24
    v_and_b32 v225, 0xffff0000, v24
    v_lshlrev_b32 v226, 16, v25
    v_and_b32 v227, 0xffff0000, v25
    v_lshlrev_b32 v228, 16, v26
    v_and_b32 v229, 0xffff0000, v26
    v_lshlrev_b32 v230, 16, v27
    v_and_b32 v231, 0xffff0000, v27
    v_lshlrev_b32 v232, 16, v28
    v_and_b32 v233, 0xffff0000, v28
    v_lshlrev_b32 v234, 16, v29
    v_and_b32 v235, 0xffff0000, v29
    v_lshlrev_b32 v236, 16, v30
    v_and_b32 v237, 0xffff0000, v30
    v_lshlrev_b32 v238, 16, v31
    v_and_b32 v239, 0xffff0000, v31
    v_pk_add_f32 v[160:161], v[224:225], v[238:239] op_sel:[0,1] op_sel_hi:[1,0]
    v_pk_add_f32 v[168:169], v[224:225], v[238:239] op_sel:[0,1] op_sel_hi:[1,0] neg_lo:[0,1] neg_hi:[0,1]
    v_pk_add_f32 v[162:163], v[226:227], v[236:237] op_sel:[0,1] op_sel_hi:[1,0]
    v_pk_add_f32 v[170:171], v[226:227], v[236:237] op_sel:[0,1] op_sel_hi:[1,0] neg_lo:[0,1] neg_hi:[0,1]
    v_pk_add_f32 v[164:165], v[228:229], v[234:235] op_sel:[0,1] op_sel_hi:[1,0]
    v_pk_add_f32 v[172:173], v[228:229], v[234:235] op_sel:[0,1] op_sel_hi:[1,0] neg_lo:[0,1] neg_hi:[0,1]
    v_pk_add_f32 v[166:167], v[230:231], v[232:233] op_sel:[0,1] op_sel_hi:[1,0]
    v_pk_add_f32 v[174:175], v[230:231], v[232:233] op_sel:[0,1] op_sel_hi:[1,0] neg_lo:[0,1] neg_hi:[0,1]
    v_pk_add_f32 v[248:249], v[160:161], v[162:163]
    v_pk_add_f32 v[240:241], v[164:165], v[166:167]
    v_pk_add_f32 v[248:249], v[248:249], v[240:241]
    v_add_f32 v143, v248, v249
    v_lshlrev_b32 v224, 16, v32
    v_and_b32 v225, 0xffff0000, v32
    v_lshlrev_b32 v226, 16, v33
    v_and_b32 v227, 0xffff0000, v33
    v_lshlrev_b32 v228, 16, v34
    v_and_b32 v229, 0xffff0000, v34
    v_lshlrev_b32 v230, 16, v35
    v_and_b32 v231, 0xffff0000, v35
    v_lshlrev_b32 v232, 16, v36
    v_and_b32 v233, 0xffff0000, v36
    v_lshlrev_b32 v234, 16, v37
    v_and_b32 v235, 0xffff0000, v37
    v_lshlrev_b32 v236, 16, v38
    v_and_b32 v237, 0xffff0000, v38
    v_lshlrev_b32 v238, 16, v39
    v_and_b32 v239, 0xffff0000, v39
    v_pk_add_f32 v[176:177], v[224:225], v[238:239] op_sel:[0,1] op_sel_hi:[1,0]
    v_pk_add_f32 v[184:185], v[224:225], v[238:239] op_sel:[0,1] op_sel_hi:[1,0] neg_lo:[0,1] neg_hi:[0,1]
    v_pk_add_f32 v[178:179], v[226:227], v[236:237] op_sel:[0,1] op_sel_hi:[1,0]
    v_pk_add_f32 v[186:187], v[226:227], v[236:237] op_sel:[0,1] op_sel_hi:[1,0] neg_lo:[0,1] neg_hi:[0,1]
    v_pk_add_f32 v[180:181], v[228:229], v[234:235] op_sel:[0,1] op_sel_hi:[1,0]
    v_pk_add_f32 v[188:189], v[228:229], v[234:235] op_sel:[0,1] op_sel_hi:[1,0] neg_lo:[0,1] neg_hi:[0,1]
    v_pk_add_f32 v[182:183], v[230:231], v[232:233] op_sel:[0,1] op_sel_hi:[1,0]
    v_pk_add_f32 v[190:191], v[230:231], v[232:233] op_sel:[0,1] op_sel_hi:[1,0] neg_lo:[0,1] neg_hi:[0,1]
    v_pk_add_f32 v[250:251], v[176:177], v[178:179]
    v_pk_add_f32 v[242:243], v[180:181], v[182:183]
    v_pk_add_f32 v[250:251], v[250:251], v[242:243]
    v_add_f32 v144, v250, v251
    v_lshlrev_b32 v224, 16, v40
    v_and_b32 v225, 0xffff0000, v40
    v_lshlrev_b32 v226, 16, v41
    v_and_b32 v227, 0xffff0000, v41
    v_lshlrev_b32 v228, 16, v42
    v_and_b32 v229, 0xffff0000, v42
    v_lshlrev_b32 v230, 16, v43
    v_and_b32 v231, 0xffff0000, v43
    v_lshlrev_b32 v232, 16, v44
    v_and_b32 v233, 0xffff0000, v44
    v_lshlrev_b32 v234, 16, v45
    v_and_b32 v235, 0xffff0000, v45
    v_lshlrev_b32 v236, 16, v46
    v_and_b32 v237, 0xffff0000, v46
    v_lshlrev_b32 v238, 16, v47
    v_and_b32 v239, 0xffff0000, v47
    v_pk_add_f32 v[192:193], v[224:225], v[238:239] op_sel:[0,1] op_sel_hi:[1,0]
    v_pk_add_f32 v[200:201], v[224:225], v[238:239] op_sel:[0,1] op_sel_hi:[1,0] neg_lo:[0,1] neg_hi:[0,1]
    v_pk_add_f32 v[194:195], v[226:227], v[236:237] op_sel:[0,1] op_sel_hi:[1,0]
    v_pk_add_f32 v[202:203], v[226:227], v[236:237] op_sel:[0,1] op_sel_hi:[1,0] neg_lo:[0,1] neg_hi:[0,1]
    v_pk_add_f32 v[196:197], v[228:229], v[234:235] op_sel:[0,1] op_sel_hi:[1,0]
    v_pk_add_f32 v[204:205], v[228:229], v[234:235] op_sel:[0,1] op_sel_hi:[1,0] neg_lo:[0,1] neg_hi:[0,1]
    v_pk_add_f32 v[198:199], v[230:231], v[232:233] op_sel:[0,1] op_sel_hi:[1,0]
    v_pk_add_f32 v[206:207], v[230:231], v[232:233] op_sel:[0,1] op_sel_hi:[1,0] neg_lo:[0,1] neg_hi:[0,1]
    v_pk_add_f32 v[252:253], v[192:193], v[194:195]
    v_pk_add_f32 v[244:245], v[196:197], v[198:199]
    v_pk_add_f32 v[252:253], v[252:253], v[244:245]
    v_add_f32 v145, v252, v253
    v_lshlrev_b32 v224, 16, v48
    v_and_b32 v225, 0xffff0000, v48
    v_lshlrev_b32 v226, 16, v49
    v_and_b32 v227, 0xffff0000, v49
    v_lshlrev_b32 v228, 16, v50
    v_and_b32 v229, 0xffff0000, v50
    v_lshlrev_b32 v230, 16, v51
    v_and_b32 v231, 0xffff0000, v51
    v_lshlrev_b32 v232, 16, v52
    v_and_b32 v233, 0xffff0000, v52
    v_lshlrev_b32 v234, 16, v53
    v_and_b32 v235, 0xffff0000, v53
    v_lshlrev_b32 v236, 16, v54
    v_and_b32 v237, 0xffff0000, v54
    v_lshlrev_b32 v238, 16, v55
    v_and_b32 v239, 0xffff0000, v55
    v_pk_add_f32 v[208:209], v[224:225], v[238:239] op_sel:[0,1] op_sel_hi:[1,0]
    v_pk_add_f32 v[216:217], v[224:225], v[238:239] op_sel:[0,1] op_sel_hi:[1,0] neg_lo:[0,1] neg_hi:[0,1]
    v_pk_add_f32 v[210:211], v[226:227], v[236:237] op_sel:[0,1] op_sel_hi:[1,0]
    v_pk_add_f32 v[218:219], v[226:227], v[236:237] op_sel:[0,1] op_sel_hi:[1,0] neg_lo:[0,1] neg_hi:[0,1]
    v_pk_add_f32 v[212:213], v[228:229], v[234:235] op_sel:[0,1] op_sel_hi:[1,0]
    v_pk_add_f32 v[220:221], v[228:229], v[234:235] op_sel:[0,1] op_sel_hi:[1,0] neg_lo:[0,1] neg_hi:[0,1]
    v_pk_add_f32 v[214:215], v[230:231], v[232:233] op_sel:[0,1] op_sel_hi:[1,0]
    v_pk_add_f32 v[222:223], v[230:231], v[232:233] op_sel:[0,1] op_sel_hi:[1,0] neg_lo:[0,1] neg_hi:[0,1]
    v_pk_add_f32 v[254:255], v[208:209], v[210:211]
    v_pk_add_f32 v[246:247], v[212:213], v[214:215]
    v_pk_add_f32 v[254:255], v[254:255], v[246:247]
    v_add_f32 v146, v254, v255
    s_lshl_b32 s54, s3, 3
    v_add_u32 v155, s54, v11
    v_lshlrev_b32 v156, 2, v155
    v_mul_u32_u24 v155, 544, v155
    v_lshl_add_u32 v155, v10, 4, v155
    v_add_f32_dpp v143, v143, v143 quad_perm:[1,0,3,2] row_mask:0xf bank_mask:0xf
    v_add_f32_dpp v144, v144, v144 quad_perm:[1,0,3,2] row_mask:0xf bank_mask:0xf
    v_add_f32_dpp v145, v145, v145 quad_perm:[1,0,3,2] row_mask:0xf bank_mask:0xf
    v_add_f32_dpp v146, v146, v146 quad_perm:[1,0,3,2] row_mask:0xf bank_mask:0xf
    v_cvt_pk_bf16_f32 v40, v168, v169
    v_cvt_pk_bf16_f32 v41, v170, v171
    v_cvt_pk_bf16_f32 v42, v172, v173
    v_cvt_pk_bf16_f32 v43, v174, v175
    ds_write_b128 v155, v[40:43] offset:17408
    v_pk_mul_f32 v[248:249], v[168:169], v[168:169]
    v_pk_fma_f32 v[248:249], v[170:171], v[170:171], v[248:249]
    v_pk_fma_f32 v[248:249], v[172:173], v[172:173], v[248:249]
    v_pk_fma_f32 v[248:249], v[174:175], v[174:175], v[248:249]
    v_add_f32_dpp v143, v143, v143 quad_perm:[2,3,0,1] row_mask:0xf bank_mask:0xf
    v_add_f32_dpp v144, v144, v144 quad_perm:[2,3,0,1] row_mask:0xf bank_mask:0xf
    v_add_f32_dpp v145, v145, v145 quad_perm:[2,3,0,1] row_mask:0xf bank_mask:0xf
    v_add_f32_dpp v146, v146, v146 quad_perm:[2,3,0,1] row_mask:0xf bank_mask:0xf
    v_cvt_pk_bf16_f32 v44, v184, v185
    v_cvt_pk_bf16_f32 v45, v186, v187
    v_cvt_pk_bf16_f32 v46, v188, v189
    v_cvt_pk_bf16_f32 v47, v190, v191
    ds_write_b128 v155, v[44:47] offset:18496
    v_pk_mul_f32 v[250:251], v[184:185], v[184:185]
    v_pk_fma_f32 v[250:251], v[186:187], v[186:187], v[250:251]
    v_pk_fma_f32 v[250:251], v[188:189], v[188:189], v[250:251]
    v_pk_fma_f32 v[250:251], v[190:191], v[190:191], v[250:251]
    v_add_f32_dpp v143, v143, v143 row_half_mirror row_mask:0xf bank_mask:0xf
    v_add_f32_dpp v144, v144, v144 row_half_mirror row_mask:0xf bank_mask:0xf
    v_add_f32_dpp v145, v145, v145 row_half_mirror row_mask:0xf bank_mask:0xf
    v_add_f32_dpp v146, v146, v146 row_half_mirror row_mask:0xf bank_mask:0xf
    v_cvt_pk_bf16_f32 v48, v200, v201
    v_cvt_pk_bf16_f32 v49, v202, v203
    v_cvt_pk_bf16_f32 v50, v204, v205
    v_cvt_pk_bf16_f32 v51, v206, v207
    ds_write_b128 v155, v[48:51] offset:19584
    v_pk_mul_f32 v[252:253], v[200:201], v[200:201]
    v_pk_fma_f32 v[252:253], v[202:203], v[202:203], v[252:253]
    v_pk_fma_f32 v[252:253], v[204:205], v[204:205], v[252:253]
    v_pk_fma_f32 v[252:253], v[206:207], v[206:207], v[252:253]
    v_add_f32_dpp v143, v143, v143 row_mirror row_mask:0xf bank_mask:0xf
    v_add_f32_dpp v144, v144, v144 row_mirror row_mask:0xf bank_mask:0xf
    v_add_f32_dpp v145, v145, v145 row_mirror row_mask:0xf bank_mask:0xf
    v_add_f32_dpp v146, v146, v146 row_mirror row_mask:0xf bank_mask:0xf
    v_cvt_pk_bf16_f32 v52, v216, v217
    v_cvt_pk_bf16_f32 v53, v218, v219
    v_cvt_pk_bf16_f32 v54, v220, v221
    v_cvt_pk_bf16_f32 v55, v222, v223
    ds_write_b128 v155, v[52:55] offset:20672
    v_pk_mul_f32 v[254:255], v[216:217], v[216:217]
    v_pk_fma_f32 v[254:255], v[218:219], v[218:219], v[254:255]
    v_pk_fma_f32 v[254:255], v[220:221], v[220:221], v[254:255]
    v_pk_fma_f32 v[254:255], v[222:223], v[222:223], v[254:255]
    v_mov_b32 v147, v143
    v_mov_b32 v148, v144
    v_mov_b32 v149, v145
    v_mov_b32 v150, v146
    v_permlane16_swap_b32 v143, v147
    v_permlane16_swap_b32 v144, v148
    v_permlane16_swap_b32 v145, v149
    v_permlane16_swap_b32 v146, v150
    v_add_f32 v143, v143, v147
    v_add_f32 v144, v144, v148
    v_add_f32 v145, v145, v149
    v_add_f32 v146, v146, v150
    v_mul_f32 v143, 0x3b124925, v143
    v_mul_f32 v144, 0x3b124925, v144
    v_mul_f32 v145, 0x3b124925, v145
    v_mul_f32 v146, 0x3b124925, v146
    v_cvt_pk_bf16_f32 v240, v143, v143
    v_lshlrev_b32 v240, 16, v240
    v_cvt_pk_bf16_f32 v242, v144, v144
    v_lshlrev_b32 v242, 16, v242
    v_cvt_pk_bf16_f32 v244, v145, v145
    v_lshlrev_b32 v244, 16, v244
    v_cvt_pk_bf16_f32 v246, v146, v146
    v_lshlrev_b32 v246, 16, v246
    v_sub_f32 v151, v143, v240
    v_add_f32 v240, v240, v240
    v_sub_f32 v152, v144, v242
    v_add_f32 v242, v242, v242
    v_sub_f32 v153, v145, v244
    v_add_f32 v244, v244, v244
    v_sub_f32 v154, v146, v246
    v_add_f32 v246, v246, v246
    v_pk_add_f32 v[160:161], v[160:161], v[240:241] op_sel_hi:[1,0] neg_lo:[0,1] neg_hi:[0,1]
    v_pk_add_f32 v[162:163], v[162:163], v[240:241] op_sel_hi:[1,0] neg_lo:[0,1] neg_hi:[0,1]
    v_pk_add_f32 v[164:165], v[164:165], v[240:241] op_sel_hi:[1,0] neg_lo:[0,1] neg_hi:[0,1]
    v_pk_add_f32 v[166:167], v[166:167], v[240:241] op_sel_hi:[1,0] neg_lo:[0,1] neg_hi:[0,1]
    v_cvt_pk_bf16_f32 v24, v160, v161
    v_cvt_pk_bf16_f32 v25, v162, v163
    v_cvt_pk_bf16_f32 v26, v164, v165
    v_cvt_pk_bf16_f32 v27, v166, v167
    ds_write_b128 v155, v[24:27] offset:0
    v_pk_add_f32 v[176:177], v[176:177], v[242:243] op_sel_hi:[1,0] neg_lo:[0,1] neg_hi:[0,1]
    v_pk_add_f32 v[178:179], v[178:179], v[242:243] op_sel_hi:[1,0] neg_lo:[0,1] neg_hi:[0,1]
    v_pk_add_f32 v[180:181], v[180:181], v[242:243] op_sel_hi:[1,0] neg_lo:[0,1] neg_hi:[0,1]
    v_pk_add_f32 v[182:183], v[182:183], v[242:243] op_sel_hi:[1,0] neg_lo:[0,1] neg_hi:[0,1]
    v_cvt_pk_bf16_f32 v28, v176, v177
    v_cvt_pk_bf16_f32 v29, v178, v179
    v_cvt_pk_bf16_f32 v30, v180, v181
    v_cvt_pk_bf16_f32 v31, v182, v183
    ds_write_b128 v155, v[28:31] offset:1088
    v_pk_add_f32 v[192:193], v[192:193], v[244:245] op_sel_hi:[1,0] neg_lo:[0,1] neg_hi:[0,1]
    v_pk_add_f32 v[194:195], v[194:195], v[244:245] op_sel_hi:[1,0] neg_lo:[0,1] neg_hi:[0,1]
    v_pk_add_f32 v[196:197], v[196:197], v[244:245] op_sel_hi:[1,0] neg_lo:[0,1] neg_hi:[0,1]
    v_pk_add_f32 v[198:199], v[198:199], v[244:245] op_sel_hi:[1,0] neg_lo:[0,1] neg_hi:[0,1]
    v_cvt_pk_bf16_f32 v32, v192, v193
    v_cvt_pk_bf16_f32 v33, v194, v195
    v_cvt_pk_bf16_f32 v34, v196, v197
    v_cvt_pk_bf16_f32 v35, v198, v199
    ds_write_b128 v155, v[32:35] offset:2176
    v_pk_add_f32 v[208:209], v[208:209], v[246:247] op_sel_hi:[1,0] neg_lo:[0,1] neg_hi:[0,1]
    v_pk_add_f32 v[210:211], v[210:211], v[246:247] op_sel_hi:[1,0] neg_lo:[0,1] neg_hi:[0,1]
    v_pk_add_f32 v[212:213], v[212:213], v[246:247] op_sel_hi:[1,0] neg_lo:[0,1] neg_hi:[0,1]
    v_pk_add_f32 v[214:215], v[214:215], v[246:247] op_sel_hi:[1,0] neg_lo:[0,1] neg_hi:[0,1]
    v_cvt_pk_bf16_f32 v36, v208, v209
    v_cvt_pk_bf16_f32 v37, v210, v211
    v_cvt_pk_bf16_f32 v38, v212, v213
    v_cvt_pk_bf16_f32 v39, v214, v215
    ds_write_b128 v155, v[36:39] offset:3264
    v_pk_fma_f32 v[248:249], v[160:161], v[160:161], v[248:249]
    v_pk_fma_f32 v[248:249], v[162:163], v[162:163], v[248:249]
    v_pk_fma_f32 v[248:249], v[164:165], v[164:165], v[248:249]
    v_pk_fma_f32 v[248:249], v[166:167], v[166:167], v[248:249]
    v_add_f32 v143, v248, v249
    v_mul_f32 v143, v143, v19
    v_pk_fma_f32 v[250:251], v[176:177], v[176:177], v[250:251]
    v_pk_fma_f32 v[250:251], v[178:179], v[178:179], v[250:251]
    v_pk_fma_f32 v[250:251], v[180:181], v[180:181], v[250:251]
    v_pk_fma_f32 v[250:251], v[182:183], v[182:183], v[250:251]
    v_add_f32 v144, v250, v251
    v_mul_f32 v144, v144, v19
    v_pk_fma_f32 v[252:253], v[192:193], v[192:193], v[252:253]
    v_pk_fma_f32 v[252:253], v[194:195], v[194:195], v[252:253]
    v_pk_fma_f32 v[252:253], v[196:197], v[196:197], v[252:253]
    v_pk_fma_f32 v[252:253], v[198:199], v[198:199], v[252:253]
    v_add_f32 v145, v252, v253
    v_mul_f32 v145, v145, v19
    v_pk_fma_f32 v[254:255], v[208:209], v[208:209], v[254:255]
    v_pk_fma_f32 v[254:255], v[210:211], v[210:211], v[254:255]
    v_pk_fma_f32 v[254:255], v[212:213], v[212:213], v[254:255]
    v_pk_fma_f32 v[254:255], v[214:215], v[214:215], v[254:255]
    v_add_f32 v146, v254, v255
    v_mul_f32 v146, v146, v19
    s_waitcnt lgkmcnt(0)
    s_barrier
    v_mul_u32_u24 v157, 544, v8
    v_lshl_add_u32 v157, v9, 4, v157
    ds_read_b128 v[184:187], v157 offset:0
    ds_read_b128 v[188:191], v157 offset:8704
    ds_read_b128 v[192:195], v157 offset:17408
    ds_read_b128 v[196:199], v157 offset:26112
    ds_read_b128 v[200:203], v157 offset:64
    ds_read_b128 v[204:207], v157 offset:8768
    ds_read_b128 v[208:211], v157 offset:17472
    ds_read_b128 v[212:215], v157 offset:26176
    ds_read_b128 v[216:219], v157 offset:128
    ds_read_b128 v[220:223], v157 offset:8832
    ds_read_b128 v[224:227], v157 offset:17536
    ds_read_b128 v[228:231], v157 offset:26240
    ds_read_b128 v[232:235], v157 offset:192
    ds_read_b128 v[236:239], v157 offset:8896
    ds_read_b128 v[240:243], v157 offset:17600
    ds_read_b128 v[244:247], v157 offset:26304
    v_add_f32_dpp v143, v143, v143 quad_perm:[1,0,3,2] row_mask:0xf bank_mask:0xf
    v_add_f32_dpp v144, v144, v144 quad_perm:[1,0,3,2] row_mask:0xf bank_mask:0xf
    v_add_f32_dpp v145, v145, v145 quad_perm:[1,0,3,2] row_mask:0xf bank_mask:0xf
    v_add_f32_dpp v146, v146, v146 quad_perm:[1,0,3,2] row_mask:0xf bank_mask:0xf
    v_add_f32_dpp v143, v143, v143 quad_perm:[2,3,0,1] row_mask:0xf bank_mask:0xf
    v_add_f32_dpp v144, v144, v144 quad_perm:[2,3,0,1] row_mask:0xf bank_mask:0xf
    v_add_f32_dpp v145, v145, v145 quad_perm:[2,3,0,1] row_mask:0xf bank_mask:0xf
    v_add_f32_dpp v146, v146, v146 quad_perm:[2,3,0,1] row_mask:0xf bank_mask:0xf
    v_add_f32_dpp v143, v143, v143 row_half_mirror row_mask:0xf bank_mask:0xf
    v_add_f32_dpp v144, v144, v144 row_half_mirror row_mask:0xf bank_mask:0xf
    v_add_f32_dpp v145, v145, v145 row_half_mirror row_mask:0xf bank_mask:0xf
    v_add_f32_dpp v146, v146, v146 row_half_mirror row_mask:0xf bank_mask:0xf
    v_add_f32_dpp v143, v143, v143 row_mirror row_mask:0xf bank_mask:0xf
    v_add_f32_dpp v144, v144, v144 row_mirror row_mask:0xf bank_mask:0xf
    s_waitcnt lgkmcnt(12)
    v_mfma_f32_16x16x32_bf16 v[160:163], v[184:187], v[60:63], 0
    v_add_f32_dpp v145, v145, v145 row_mirror row_mask:0xf bank_mask:0xf
    v_add_f32_dpp v146, v146, v146 row_mirror row_mask:0xf bank_mask:0xf
    v_mov_b32 v147, v143
    v_mfma_f32_16x16x32_bf16 v[164:167], v[188:191], v[60:63], 0
    v_mov_b32 v148, v144
    v_mov_b32 v149, v145
    v_mov_b32 v150, v146
    v_mfma_f32_16x16x32_bf16 v[168:171], v[192:195], v[88:91], 0
    v_permlane16_swap_b32 v143, v147
    v_permlane16_swap_b32 v144, v148
    v_permlane16_swap_b32 v145, v149
    v_mfma_f32_16x16x32_bf16 v[172:175], v[196:199], v[88:91], 0
    v_permlane16_swap_b32 v146, v150
    v_add_f32 v143, v143, v147
    v_add_f32 v144, v144, v148
    ds_read_b128 v[184:187], v157 offset:256
    ds_read_b128 v[188:191], v157 offset:8960
    ds_read_b128 v[192:195], v157 offset:17664
    ds_read_b128 v[196:199], v157 offset:26368
    s_waitcnt lgkmcnt(12)
    v_mfma_f32_16x16x32_bf16 v[160:163], v[200:203], v[64:67], v[160:163]
    v_add_f32 v145, v145, v149
    v_add_f32 v146, v146, v150
    v_mul_f32 v143, 0x3a924925, v143
    v_mfma_f32_16x16x32_bf16 v[164:167], v[204:207], v[64:67], v[164:167]
    v_mul_f32 v144, 0x3a924925, v144
    v_mul_f32 v145, 0x3a924925, v145
    v_mul_f32 v146, 0x3a924925, v146
    v_mfma_f32_16x16x32_bf16 v[168:171], v[208:211], v[92:95], v[168:171]
    v_fma_f32 v143, -v151, v151, v143
    v_fma_f32 v144, -v152, v152, v144
    v_fma_f32 v145, -v153, v153, v145
    v_mfma_f32_16x16x32_bf16 v[172:175], v[212:215], v[92:95], v[172:175]
    v_fma_f32 v146, -v154, v154, v146
    v_max_f32 v143, 0, v143
    v_max_f32 v144, 0, v144
    ds_read_b128 v[200:203], v157 offset:320
    ds_read_b128 v[204:207], v157 offset:9024
    ds_read_b128 v[208:211], v157 offset:17728
    ds_read_b128 v[212:215], v157 offset:26432
    s_waitcnt lgkmcnt(12)
    v_mfma_f32_16x16x32_bf16 v[160:163], v[216:219], v[68:71], v[160:163]
    v_max_f32 v145, 0, v145
    v_max_f32 v146, 0, v146
    v_cvt_pk_bf16_f32 v143, v143, v143
    v_mfma_f32_16x16x32_bf16 v[164:167], v[220:223], v[68:71], v[164:167]
    v_cvt_pk_bf16_f32 v144, v144, v144
    v_cvt_pk_bf16_f32 v145, v145, v145
    v_cvt_pk_bf16_f32 v146, v146, v146
    v_mfma_f32_16x16x32_bf16 v[168:171], v[224:227], v[96:99], v[168:171]
    v_lshlrev_b32 v143, 16, v143
    v_lshlrev_b32 v144, 16, v144
    v_lshlrev_b32 v145, 16, v145
    v_mfma_f32_16x16x32_bf16 v[172:175], v[228:231], v[96:99], v[172:175]
    v_lshlrev_b32 v146, 16, v146
    v_add_f32 v143, 0x3727c5ac, v143
    v_add_f32 v144, 0x3727c5ac, v144
    ds_read_b128 v[216:219], v157 offset:384
    ds_read_b128 v[220:223], v157 offset:9088
    ds_read_b128 v[224:227], v157 offset:17792
    ds_read_b128 v[228:231], v157 offset:26496
    s_waitcnt lgkmcnt(12)
    v_mfma_f32_16x16x32_bf16 v[160:163], v[232:235], v[72:75], v[160:163]
    v_add_f32 v145, 0x3727c5ac, v145
    v_add_f32 v146, 0x3727c5ac, v146
    v_cvt_pk_bf16_f32 v143, v143, v143
    v_mfma_f32_16x16x32_bf16 v[164:167], v[236:239], v[72:75], v[164:167]
    v_cvt_pk_bf16_f32 v144, v144, v144
    v_cvt_pk_bf16_f32 v145, v145, v145
    v_cvt_pk_bf16_f32 v146, v146, v146
    v_mfma_f32_16x16x32_bf16 v[168:171], v[240:243], v[100:103], v[168:171]
    v_lshlrev_b32 v143, 16, v143
    v_lshlrev_b32 v144, 16, v144
    v_lshlrev_b32 v145, 16, v145
    v_mfma_f32_16x16x32_bf16 v[172:175], v[244:247], v[100:103], v[172:175]
    v_lshlrev_b32 v146, 16, v146
    v_sqrt_f32 v143, v143
    v_sqrt_f32 v144, v144
    s_waitcnt lgkmcnt(8)
    v_mfma_f32_16x16x32_bf16 v[160:163], v[184:187], v[76:79], v[160:163]
    v_sqrt_f32 v145, v145
    v_sqrt_f32 v146, v146
    v_cvt_pk_bf16_f32 v143, v143, v143
    v_mfma_f32_16x16x32_bf16 v[164:167], v[188:191], v[76:79], v[164:167]
    v_cvt_pk_bf16_f32 v144, v144, v144
    v_cvt_pk_bf16_f32 v145, v145, v145
    v_cvt_pk_bf16_f32 v146, v146, v146
    v_mfma_f32_16x16x32_bf16 v[168:171], v[192:195], v[104:107], v[168:171]
    v_lshlrev_b32 v143, 16, v143
    v_lshlrev_b32 v144, 16, v144
    v_lshlrev_b32 v145, 16, v145
    v_mfma_f32_16x16x32_bf16 v[172:175], v[196:199], v[104:107], v[172:175]
    v_lshlrev_b32 v146, 16, v146
    v_rcp_f32 v143, v143
    v_rcp_f32 v144, v144
    s_waitcnt lgkmcnt(4)
    v_mfma_f32_16x16x32_bf16 v[160:163], v[200:203], v[80:83], v[160:163]
    v_rcp_f32 v145, v145
    v_rcp_f32 v146, v146
    ds_write_b32 v156, v143 offset:34816
    v_mfma_f32_16x16x32_bf16 v[164:167], v[204:207], v[80:83], v[164:167]
    ds_write_b32 v156, v144 offset:34824
    ds_write_b32 v156, v145 offset:34832
    ds_write_b32 v156, v146 offset:34840
    v_mfma_f32_16x16x32_bf16 v[168:171], v[208:211], v[108:111], v[168:171]
    v_mfma_f32_16x16x32_bf16 v[172:175], v[212:215], v[108:111], v[172:175]
    s_waitcnt lgkmcnt(4)
    v_mfma_f32_16x16x32_bf16 v[160:163], v[216:219], v[84:87], v[160:163]
    v_mfma_f32_16x16x32_bf16 v[164:167], v[220:223], v[84:87], v[164:167]
    v_mfma_f32_16x16x32_bf16 v[168:171], v[224:227], v[112:115], v[168:171]
    v_mfma_f32_16x16x32_bf16 v[172:175], v[228:231], v[112:115], v[172:175]
    v_lshlrev_b32 v156, 4, v9
    s_waitcnt lgkmcnt(0)
    s_barrier
    ds_read_b128 v[176:179], v156 offset:34816
    ds_read_b128 v[180:183], v156 offset:34880
    s_waitcnt lgkmcnt(0)
    v_pk_mul_f32 v[160:161], v[160:161], v[176:177]
    v_pk_mul_f32 v[168:169], v[168:169], v[176:177]
    v_pk_mul_f32 v[162:163], v[162:163], v[178:179]
    v_pk_mul_f32 v[170:171], v[170:171], v[178:179]
    v_pk_mul_f32 v[164:165], v[164:165], v[180:181]
    v_pk_mul_f32 v[172:173], v[172:173], v[180:181]
    v_pk_mul_f32 v[166:167], v[166:167], v[182:183]
    v_pk_mul_f32 v[174:175], v[174:175], v[182:183]
    v_cvt_pk_bf16_f32 v248, v160, v161
    v_cvt_pk_bf16_f32 v249, v162, v163
    v_cvt_pk_bf16_f32 v250, v164, v165
    v_cvt_pk_bf16_f32 v251, v166, v167
    v_cvt_pk_bf16_f32 v252, v168, v169
    v_cvt_pk_bf16_f32 v253, v170, v171
    v_cvt_pk_bf16_f32 v254, v172, v173
    v_cvt_pk_bf16_f32 v255, v174, v175
    v_mfma_f32_16x16x32_bf16 v[24:27], v[116:119], v[248:251], 0
    v_mfma_f32_16x16x32_bf16 v[32:35], v[132:135], v[248:251], 0
    v_mfma_f32_16x16x32_bf16 v[28:31], v[120:123], v[248:251], 0
    v_mfma_f32_16x16x32_bf16 v[36:39], v[136:139], v[248:251], 0
    v_mfma_f32_16x16x32_bf16 v[24:27], v[124:127], v[252:255], v[24:27]
    v_mfma_f32_16x16x32_bf16 v[32:35], v[116:119], v[252:255], v[32:35]
    v_mfma_f32_16x16x32_bf16 v[28:31], v[128:131], v[252:255], v[28:31]
    v_mfma_f32_16x16x32_bf16 v[36:39], v[120:123], v[252:255], v[36:39]
    s_nop 5
    v_cvt_pk_bf16_f32 v184, v24, v32
    v_cvt_pk_bf16_f32 v185, v25, v33
    v_cvt_pk_bf16_f32 v186, v26, v34
    v_cvt_pk_bf16_f32 v187, v27, v35
    v_cvt_pk_bf16_f32 v188, v28, v36
    v_cvt_pk_bf16_f32 v189, v29, v37
    v_cvt_pk_bf16_f32 v190, v30, v38
    v_cvt_pk_bf16_f32 v191, v31, v39
    s_mov_b32 vcc_lo, 0x55555555
    s_mov_b32 vcc_hi, 0x55555555
    v_cndmask_b32_dpp v192, v185, v184, vcc quad_perm:[1,0,3,2] row_mask:0xf bank_mask:0xf
    v_cndmask_b32_dpp v194, v187, v186, vcc quad_perm:[1,0,3,2] row_mask:0xf bank_mask:0xf
    v_cndmask_b32_dpp v196, v189, v188, vcc quad_perm:[1,0,3,2] row_mask:0xf bank_mask:0xf
    v_cndmask_b32_dpp v198, v191, v190, vcc quad_perm:[1,0,3,2] row_mask:0xf bank_mask:0xf
    s_mov_b32 vcc_lo, 0xaaaaaaaa
    s_mov_b32 vcc_hi, 0xaaaaaaaa
    v_cndmask_b32_dpp v193, v184, v185, vcc quad_perm:[1,0,3,2] row_mask:0xf bank_mask:0xf
    v_cndmask_b32_dpp v195, v186, v187, vcc quad_perm:[1,0,3,2] row_mask:0xf bank_mask:0xf
    v_cndmask_b32_dpp v197, v188, v189, vcc quad_perm:[1,0,3,2] row_mask:0xf bank_mask:0xf
    v_cndmask_b32_dpp v199, v190, v191, vcc quad_perm:[1,0,3,2] row_mask:0xf bank_mask:0xf
    s_mov_b32 vcc_lo, 0x33333333
    s_mov_b32 vcc_hi, 0x33333333
    v_cndmask_b32_dpp v200, v194, v192, vcc quad_perm:[2,3,0,1] row_mask:0xf bank_mask:0xf
    v_cndmask_b32_dpp v201, v195, v193, vcc quad_perm:[2,3,0,1] row_mask:0xf bank_mask:0xf
    v_cndmask_b32_dpp v204, v198, v196, vcc quad_perm:[2,3,0,1] row_mask:0xf bank_mask:0xf
    v_cndmask_b32_dpp v205, v199, v197, vcc quad_perm:[2,3,0,1] row_mask:0xf bank_mask:0xf
    s_mov_b32 vcc_lo, 0xcccccccc
    s_mov_b32 vcc_hi, 0xcccccccc
    v_cndmask_b32_dpp v202, v192, v194, vcc quad_perm:[2,3,0,1] row_mask:0xf bank_mask:0xf
    v_cndmask_b32_dpp v203, v193, v195, vcc quad_perm:[2,3,0,1] row_mask:0xf bank_mask:0xf
    v_cndmask_b32_dpp v206, v196, v198, vcc quad_perm:[2,3,0,1] row_mask:0xf bank_mask:0xf
    v_cndmask_b32_dpp v207, v197, v199, vcc quad_perm:[2,3,0,1] row_mask:0xf bank_mask:0xf
    s_mov_b32 s54, 0x100000
    buffer_store_dwordx4 v[200:203], v142, s[12:15], 0 offen sc0 sc1
    buffer_store_dwordx4 v[204:207], v142, s[12:15], s54 offen sc0 sc1
    s_load_dwordx2 s[96:97], s[0:1], 56
    s_mov_b32 s55, s88
    v_mov_b32 v6, v56
    v_mov_b32 v7, v22
    v_mov_b32 v4, v20
    v_mov_b32 v5, v21
    v_mov_b32 v16, v4
    v_mov_b32 v17, v5
    v_mov_b32 v18, v6
    v_mov_b32 v19, v7
    s_lshr_b32 s90, s2, 6
    s_lshl_b32 s90, s90, 6
    s_lshl_b32 s60, s2, 7
    s_add_u32 s60, s60, 98304
    v_mov_b32 v4, 1
    v_lshlrev_b32 v5, 20, v0
    v_lshlrev_b32 v200, 7, v0
    v_and_b32 v6, 0xffffe000, v200
    v_lshl_add_u32 v200, v6, 12, v200
    s_waitcnt vmcnt(0)
    s_barrier
    buffer_store_dword v4, v5, s[56:59], s60 offen sc0 sc1
    s_lshl_b32 s61, s2, 2
    s_add_u32 s61, s61, s3
    s_add_u32 s61, s61, 0
    s_lshl_b32 s92, s61, 10
    s_cmp_ge_u32 s61, 1568
    s_cselect_b32 s92, 0x40000000, s92
    s_cselect_b32 s61, 0, s61
    s_mul_i32 s62, s61, 9363
    s_lshr_b32 s62, s62, 20
    s_mul_i32 s63, s62, 112
    s_sub_u32 s61, s61, s63
    s_mul_i32 s61, s61, 14336
    s_lshl_b32 s62, s62, 6
    s_add_u32 s61, s61, s62
    s_add_u32 m0, s55, 28672
    s_nop 0
    buffer_load_dwordx4 v19, s[24:27], s61 offen lds
    s_lshl_b32 s61, s2, 2
    s_add_u32 s61, s61, s3
    s_add_u32 s61, s61, 1024
    s_lshl_b32 s93, s61, 10
    s_cmp_ge_u32 s61, 1568
    s_cselect_b32 s93, 0x40000000, s93
    s_cselect_b32 s61, 0, s61
    s_mul_i32 s62, s61, 9363
    s_lshr_b32 s62, s62, 20
    s_mul_i32 s63, s62, 112
    s_sub_u32 s61, s61, s63
    s_mul_i32 s61, s61, 14336
    s_lshl_b32 s62, s62, 6
    s_add_u32 s61, s61, s62
    s_add_u32 m0, s55, 29696
    s_nop 0
    buffer_load_dwordx4 v19, s[24:27], s61 offen lds
    s_waitcnt lgkmcnt(0)
    s_mov_b32 s48, s96
    s_mov_b32 s49, s97
    s_mov_b32 s50, 0x1c0000
    s_mov_b32 s51, 0x00020000
    s_add_u32 s20, s6, 0x400000
    s_addc_u32 s21, s7, 0
    s_mov_b32 s22, 0x1c0000
    s_mov_b32 s23, 0x00020000
    s_add_u32 s24, s6, 0xe00000
    s_addc_u32 s25, s7, 0
    s_mov_b32 s26, 0x700000
    s_mov_b32 s27, 0x00020000
    s_add_u32 s96, s6, 0xc80000
    s_addc_u32 s97, s7, 0
    s_mov_b32 s98, 0x40000
    s_mov_b32 s99, 0x00020000
    s_mov_b32 s88, s52
    s_mov_b32 s89, s53
    s_and_b32 s60, s2, 31
    s_lshr_b32 s61, s2, 5
    s_lshr_b32 s62, s3, 1
    s_lshl_b32 s61, s61, 1
    s_add_u32 s61, s61, s62
    s_and_b32 s62, s3, 1
    s_lshl_b32 s63, s61, 4
    v_add_u32 v120, s63, v8
    s_add_u32 m0, s55, 0
    s_mov_b32 s54, 0
    buffer_load_dwordx4 v16, s[36:39], s54 offen lds
    s_lshl_b32 s63, s60, 16
    v_lshlrev_b32 v121, 12, v9
    v_and_b32 v5, 3, v8
    v_and_b32 v6, 0xfc, v120
    v_lshl_add_u32 v121, v120, 2, v121
    v_add_u32 v121, s63, v121
    v_lshlrev_b32 v123, 17, v9
    v_lshl_add_u32 v123, v5, 15, v123
    v_lshl_add_u32 v123, v6, 2, v123
    s_lshl_b32 s63, s62, 10
    s_add_u32 s63, s63, s60
    v_lshlrev_b32 v122, 7, v9
    v_add_u32 v122, s63, v122
    v_mul_u32_u24 v122, 450, v122
    v_lshl_add_u32 v122, v120, 1, v122
    v_cmp_gt_u32 vcc, 225, v120
    v_mov_b32 v4, 0x40000000
    s_nop 0
    v_cndmask_b32 v122, v4, v122, vcc
    s_add_u32 m0, s55, 1024
    s_mov_b32 s54, 0
    buffer_load_dwordx4 v16, s[40:43], s54 offen lds
    v_mov_b32 v144, 0
    v_mov_b32 v152, 0
    v_mov_b32 v145, 0
    v_mov_b32 v153, 0
    v_mov_b32 v146, 0
    v_mov_b32 v154, 0
    v_mov_b32 v147, 0
    v_mov_b32 v155, 0
    v_mov_b32 v148, 0
    v_mov_b32 v156, 0
    v_mov_b32 v149, 0
    v_mov_b32 v157, 0
    v_mov_b32 v150, 0
    v_mov_b32 v158, 0
    v_mov_b32 v151, 0
    v_mov_b32 v159, 0
    v_mov_b32 v124, 0x36124925
    v_mov_b32 v4, 0x35924925
    s_add_u32 m0, s55, 2048
    s_mov_b32 s54, 57344
    buffer_load_dwordx4 v16, s[36:39], s54 offen lds
    v_cmp_eq_u32 vcc, 0, v120
    s_nop 1
    v_cndmask_b32 v124, v124, v4, vcc
    v_cmp_eq_u32 vcc, 224, v120
    s_nop 1
    v_cndmask_b32 v124, v124, v4, vcc
    s_lshl_b32 s63, s62, 20
    s_lshl_b32 s61, s60, 10
    s_add_u32 s63, s63, s61
    v_add_u32 v123, s63, v123
    v_lshlrev_b32 v4, 6, v8
    v_add_u32 v4, s88, v4
    v_mul_u32_u24 v4, 896, v4
    s_lshl_b32 s63, s89, 5
    v_lshlrev_b32 v5, 3, v9
    v_add_u32 v5, s63, v5
    v_add_u32 v125, v4, v5
    v_sub_u32 v126, v4, v5
    v_add_u32 v126, 888, v126
    s_lshl_b32 s63, s88, 5
    v_add_u32 v4, s63, v8
    s_add_u32 m0, s55, 3072
    s_mov_b32 s54, 57344
    buffer_load_dwordx4 v16, s[40:43], s54 offen lds
    v_mul_u32_u24 v4, 896, v4
    v_add_u32 v116, v4, v5
    v_sub_u32 v117, v4, v5
    v_add_u32 v117, 888, v117
    v_cvt_f32_u32 v127, v9
    s_and_b32 s63, s3, 1
    s_cmp_eq_u32 s63, 0
    s_cselect_b32 s60, 0, 0.5
    s_lshl_b32 s63, s63, 5
    v_mul_f32 v4, 0x3d800000, v127
    v_add_f32 v4, s60, v4
    v_add_u32 v226, s63, v8
    v_cvt_f32_u32 v226, v226
    v_and_b32 v227, 1, v8
    v_mul_u32_u24 v227, 0x8000, v227
    v_lshl_add_u32 v227, v227, 16, v227
    v_add_f32 v202, 0x00000000, v4
    v_add_f32 v203, 0x3c800000, v4
    s_add_u32 m0, s55, 4096
    s_mov_b32 s54, 114688
    buffer_load_dwordx4 v16, s[36:39], s54 offen lds
    v_add_f32 v204, 0x3d000000, v4
    v_add_f32 v205, 0x3d400000, v4
    v_add_f32 v206, 0x3e800000, v4
    v_add_f32 v207, 0x3e880000, v4
    v_add_f32 v208, 0x3e900000, v4
    v_add_f32 v209, 0x3e980000, v4
    v_mul_f32 v202, v226, v202
    v_mul_f32 v203, v226, v203
    v_mul_f32 v204, v226, v204
    v_mul_f32 v205, v226, v205
    v_mul_f32 v206, v226, v206
    v_mul_f32 v207, v226, v207
    v_mul_f32 v208, v226, v208
    v_mul_f32 v209, v226, v209
    v_fract_f32 v202, v202
    v_fract_f32 v203, v203
    v_fract_f32 v204, v204
    v_fract_f32 v205, v205
    s_add_u32 m0, s55, 5120
    s_mov_b32 s54, 114688
    buffer_load_dwordx4 v16, s[40:43], s54 offen lds
    v_fract_f32 v206, v206
    v_fract_f32 v207, v207
    v_fract_f32 v208, v208
    v_fract_f32 v209, v209
    v_cos_f32 v210, v202
    v_sin_f32 v218, v202
    v_cos_f32 v211, v203
    v_sin_f32 v219, v203
    v_cos_f32 v212, v204
    v_sin_f32 v220, v204
    v_cos_f32 v213, v205
    v_sin_f32 v221, v205
    v_cos_f32 v214, v206
    v_sin_f32 v222, v206
    v_cos_f32 v215, v207
    v_sin_f32 v223, v207
    v_cos_f32 v216, v208
    v_sin_f32 v224, v208
    s_add_u32 m0, s55, 6144
    s_mov_b32 s54, 172032
    buffer_load_dwordx4 v16, s[36:39], s54 offen lds
    v_cos_f32 v217, v209
    v_sin_f32 v225, v209
    v_cvt_pk_bf16_f32 v160, v210, v211
    v_cvt_pk_bf16_f32 v164, v218, v219
    v_cvt_pk_bf16_f32 v176, v210, -v219
    v_cvt_pk_bf16_f32 v180, v218, v211
    v_cvt_pk_bf16_f32 v161, v212, v213
    v_cvt_pk_bf16_f32 v165, v220, v221
    v_cvt_pk_bf16_f32 v177, -v212, v221
    v_cvt_pk_bf16_f32 v181, -v220, -v213
    v_cvt_pk_bf16_f32 v162, v214, v215
    v_cvt_pk_bf16_f32 v166, v222, v223
    v_cvt_pk_bf16_f32 v178, v214, -v223
    v_cvt_pk_bf16_f32 v182, v222, v215
    v_cvt_pk_bf16_f32 v163, v216, v217
    v_cvt_pk_bf16_f32 v167, v224, v225
    v_cvt_pk_bf16_f32 v179, -v216, v225
    v_cvt_pk_bf16_f32 v183, -v224, -v217
    s_add_u32 m0, s55, 7168
    s_mov_b32 s54, 172032
    buffer_load_dwordx4 v16, s[40:43], s54 offen lds
    v_xor_b32 v168, v227, v160
    v_xor_b32 v169, v227, v161
    v_xor_b32 v170, v227, v162
    v_xor_b32 v171, v227, v163
    v_xor_b32 v172, v227, v164
    v_xor_b32 v173, v227, v165
    v_xor_b32 v174, v227, v166
    v_xor_b32 v175, v227, v167
    v_xor_b32 v184, v227, v176
    v_xor_b32 v185, v227, v177
    v_xor_b32 v186, v227, v178
    v_xor_b32 v187, v227, v179
    v_xor_b32 v188, v227, v180
    v_xor_b32 v189, v227, v181
    v_xor_b32 v190, v227, v182
    v_xor_b32 v191, v227, v183
    s_lshl_b32 s63, s89, 5
    v_lshl_add_u32 v201, v8, 1, s63
    s_add_u32 m0, s55, 8192
    s_mov_b32 s54, 229376
    buffer_load_dwordx4 v16, s[36:39], s54 offen lds
    v_add_u32 v201, 1, v201
    v_cvt_f32_u32 v201, v201
    v_mul_f32 v240, 0x3a924925, v201
    v_mul_f32 v239, 0x41000000, v127
    v_mov_b32 v238, 0x42000000
    v_mul_f32 v238, v238, v201
    v_mul_f32 v235, 0x3a924925, v238
    v_floor_f32 v235, v235
    v_fma_f32 v238, v235, s91, v238
    v_mul_f32 v238, 0x3a924925, v238
    v_cos_f32 v238, v238
    v_add_f32 v234, 0x00000000, v239
    v_mul_f32 v234, v234, v201
    v_mul_f32 v235, 0x3a924925, v234
    v_floor_f32 v235, v235
    v_fma_f32 v234, v235, s91, v234
    v_mul_f32 v234, 0x3a924925, v234
    v_add_f32 v238, v238, v238
    s_add_u32 m0, s55, 9216
    s_mov_b32 s54, 229376
    buffer_load_dwordx4 v16, s[40:43], s54 offen lds
    v_mov_b32 v236, v234
    v_fma_f32 v237, v240, 1.0, v234
    v_cos_f32 v202, v236
    v_cos_f32 v203, v237
    v_sin_f32 v218, v236
    v_sin_f32 v219, v237
    v_fma_f32 v236, v240, 2.0, v234
    v_mov_b32 v237, 0x40400000
    v_fma_f32 v237, v240, v237, v234
    v_cos_f32 v204, v236
    v_cos_f32 v205, v237
    v_sin_f32 v220, v236
    v_sin_f32 v221, v237
    v_fma_f32 v236, v240, 4.0, v234
    v_mov_b32 v237, 0x40a00000
    v_fma_f32 v237, v240, v237, v234
    v_cos_f32 v206, v236
    v_cos_f32 v207, v237
    s_add_u32 m0, s55, 10240
    s_mov_b32 s54, 286720
    buffer_load_dwordx4 v16, s[36:39], s54 offen lds
    v_sin_f32 v222, v236
    v_sin_f32 v223, v237
    v_mov_b32 v236, 0x40c00000
    v_fma_f32 v236, v240, v236, v234
    v_mov_b32 v237, 0x40e00000
    v_fma_f32 v237, v240, v237, v234
    v_cos_f32 v208, v236
    v_cos_f32 v209, v237
    v_sin_f32 v224, v236
    v_sin_f32 v225, v237
    v_cvt_pk_bf16_f32 v52, v202, v203
    v_cvt_pk_bf16_f32 v80, v218, v219
    v_cvt_pk_bf16_f32 v53, v204, v205
    v_cvt_pk_bf16_f32 v81, v220, v221
    v_cvt_pk_bf16_f32 v54, v206, v207
    v_cvt_pk_bf16_f32 v82, v222, v223
    v_cvt_pk_bf16_f32 v55, v208, v209
    v_cvt_pk_bf16_f32 v83, v224, v225
    s_add_u32 m0, s55, 11264
    s_mov_b32 s54, 286720
    buffer_load_dwordx4 v16, s[40:43], s54 offen lds
    v_add_f32 v234, 0x42000000, v239
    v_mul_f32 v234, v234, v201
    v_mul_f32 v235, 0x3a924925, v234
    v_floor_f32 v235, v235
    v_fma_f32 v234, v235, s91, v234
    v_mul_f32 v234, 0x3a924925, v234
    v_mov_b32 v236, v234
    v_fma_f32 v237, v240, 1.0, v234
    v_cos_f32 v210, v236
    v_cos_f32 v211, v237
    v_sin_f32 v226, v236
    v_sin_f32 v227, v237
    v_fma_f32 v236, v240, 2.0, v234
    v_mov_b32 v237, 0x40400000
    v_fma_f32 v237, v240, v237, v234
    v_cos_f32 v212, v236
    v_cos_f32 v213, v237
    v_sin_f32 v228, v236
    s_add_u32 m0, s55, 12288
    s_mov_b32 s54, 344064
    buffer_load_dwordx4 v16, s[36:39], s54 offen lds
    v_sin_f32 v229, v237
    v_fma_f32 v236, v240, 4.0, v234
    v_mov_b32 v237, 0x40a00000
    v_fma_f32 v237, v240, v237, v234
    v_cos_f32 v214, v236
    v_cos_f32 v215, v237
    v_sin_f32 v230, v236
    v_sin_f32 v231, v237
    v_mov_b32 v236, 0x40c00000
    v_fma_f32 v236, v240, v236, v234
    v_mov_b32 v237, 0x40e00000
    v_fma_f32 v237, v240, v237, v234
    v_cos_f32 v216, v236
    v_cos_f32 v217, v237
    v_sin_f32 v232, v236
    v_sin_f32 v233, v237
    v_cvt_pk_bf16_f32 v56, v210, v211
    v_cvt_pk_bf16_f32 v84, v226, v227
    s_add_u32 m0, s55, 13312
    s_mov_b32 s54, 344064
    buffer_load_dwordx4 v16, s[40:43], s54 offen lds
    v_cvt_pk_bf16_f32 v57, v212, v213
    v_cvt_pk_bf16_f32 v85, v228, v229
    v_cvt_pk_bf16_f32 v58, v214, v215
    v_cvt_pk_bf16_f32 v86, v230, v231
    v_cvt_pk_bf16_f32 v59, v216, v217
    v_cvt_pk_bf16_f32 v87, v232, v233
    v_fma_f32 v202, v238, v210, -v202
    v_fma_f32 v218, v238, v226, -v218
    v_fma_f32 v203, v238, v211, -v203
    v_fma_f32 v219, v238, v227, -v219
    v_fma_f32 v204, v238, v212, -v204
    v_fma_f32 v220, v238, v228, -v220
    v_fma_f32 v205, v238, v213, -v205
    v_fma_f32 v221, v238, v229, -v221
    v_fma_f32 v206, v238, v214, -v206
    v_fma_f32 v222, v238, v230, -v222
    v_fma_f32 v207, v238, v215, -v207
    v_fma_f32 v223, v238, v231, -v223
    s_add_u32 m0, s55, 14336
    s_mov_b32 s54, 401408
    buffer_load_dwordx4 v16, s[36:39], s54 offen lds
    v_fma_f32 v208, v238, v216, -v208
    v_fma_f32 v224, v238, v232, -v224
    v_fma_f32 v209, v238, v217, -v209
    v_fma_f32 v225, v238, v233, -v225
    v_cvt_pk_bf16_f32 v60, v202, v203
    v_cvt_pk_bf16_f32 v88, v218, v219
    v_cvt_pk_bf16_f32 v61, v204, v205
    v_cvt_pk_bf16_f32 v89, v220, v221
    v_cvt_pk_bf16_f32 v62, v206, v207
    v_cvt_pk_bf16_f32 v90, v222, v223
    v_cvt_pk_bf16_f32 v63, v208, v209
    v_cvt_pk_bf16_f32 v91, v224, v225
    v_fma_f32 v210, v238, v202, -v210
    v_fma_f32 v226, v238, v218, -v226
    v_fma_f32 v211, v238, v203, -v211
    v_fma_f32 v227, v238, v219, -v227
    v_fma_f32 v212, v238, v204, -v212
    v_fma_f32 v228, v238, v220, -v228
    s_add_u32 m0, s55, 15360
    s_mov_b32 s54, 401408
    buffer_load_dwordx4 v16, s[40:43], s54 offen lds
    v_fma_f32 v213, v238, v205, -v213
    v_fma_f32 v229, v238, v221, -v229
    v_fma_f32 v214, v238, v206, -v214
    v_fma_f32 v230, v238, v222, -v230
    v_fma_f32 v215, v238, v207, -v215
    v_fma_f32 v231, v238, v223, -v231
    v_fma_f32 v216, v238, v208, -v216
    v_fma_f32 v232, v238, v224, -v232
    v_fma_f32 v217, v238, v209, -v217
    v_fma_f32 v233, v238, v225, -v233
    v_cvt_pk_bf16_f32 v64, v210, v211
    v_cvt_pk_bf16_f32 v92, v226, v227
    v_cvt_pk_bf16_f32 v65, v212, v213
    v_cvt_pk_bf16_f32 v93, v228, v229
    v_cvt_pk_bf16_f32 v66, v214, v215
    v_cvt_pk_bf16_f32 v94, v230, v231
    v_cvt_pk_bf16_f32 v67, v216, v217
    v_cvt_pk_bf16_f32 v95, v232, v233
    s_lshl_b32 s62, s90, 7
    s_add_u32 s62, s62, 98304
    buffer_load_dword v192, v200, s[56:59], s62 offen sc0 sc1
    v_lshrrev_b32 v197, 2, v200
    buffer_load_dword v196, v197, s[16:19], 0 offen sc0 sc1
    v_fma_f32 v202, v238, v210, -v202
    v_fma_f32 v218, v238, v226, -v218
    v_fma_f32 v203, v238, v211, -v203
    v_fma_f32 v219, v238, v227, -v219
    v_fma_f32 v204, v238, v212, -v204
    v_fma_f32 v220, v238, v228, -v220
    v_fma_f32 v205, v238, v213, -v205
    v_fma_f32 v221, v238, v229, -v221
    v_fma_f32 v206, v238, v214, -v206
    v_fma_f32 v222, v238, v230, -v222
    v_fma_f32 v207, v238, v215, -v207
    v_fma_f32 v223, v238, v231, -v223
    v_fma_f32 v208, v238, v216, -v208
    v_fma_f32 v224, v238, v232, -v224
    v_fma_f32 v209, v238, v217, -v209
    v_fma_f32 v225, v238, v233, -v225
    v_cvt_pk_bf16_f32 v68, v202, v203
    v_cvt_pk_bf16_f32 v96, v218, v219
    v_cvt_pk_bf16_f32 v69, v204, v205
    v_cvt_pk_bf16_f32 v97, v220, v221
    v_cvt_pk_bf16_f32 v70, v206, v207
    v_cvt_pk_bf16_f32 v98, v222, v223
    v_cvt_pk_bf16_f32 v71, v208, v209
    v_cvt_pk_bf16_f32 v99, v224, v225
    v_fma_f32 v210, v238, v202, -v210
    v_fma_f32 v226, v238, v218, -v226
    v_fma_f32 v211, v238, v203, -v211
    v_fma_f32 v227, v238, v219, -v227
    v_fma_f32 v212, v238, v204, -v212
    v_fma_f32 v228, v238, v220, -v228
    v_fma_f32 v213, v238, v205, -v213
    v_fma_f32 v229, v238, v221, -v229
    v_fma_f32 v214, v238, v206, -v214
    v_fma_f32 v230, v238, v222, -v230
    v_fma_f32 v215, v238, v207, -v215
    v_fma_f32 v231, v238, v223, -v231
    v_fma_f32 v216, v238, v208, -v216
    v_fma_f32 v232, v238, v224, -v232
    v_fma_f32 v217, v238, v209, -v217
    v_fma_f32 v233, v238, v225, -v233
    v_cvt_pk_bf16_f32 v72, v210, v211
    v_cvt_pk_bf16_f32 v100, v226, v227
    v_cvt_pk_bf16_f32 v73, v212, v213
    v_cvt_pk_bf16_f32 v101, v228, v229
    v_cvt_pk_bf16_f32 v74, v214, v215
    v_cvt_pk_bf16_f32 v102, v230, v231
    v_cvt_pk_bf16_f32 v75, v216, v217
    v_cvt_pk_bf16_f32 v103, v232, v233
    v_fma_f32 v202, v238, v210, -v202
    v_fma_f32 v218, v238, v226, -v218
    v_fma_f32 v203, v238, v211, -v203
    v_fma_f32 v219, v238, v227, -v219
    v_fma_f32 v204, v238, v212, -v204
    v_fma_f32 v220, v238, v228, -v220
    v_fma_f32 v205, v238, v213, -v205
    v_fma_f32 v221, v238, v229, -v221
    v_fma_f32 v206, v238, v214, -v206
    v_fma_f32 v222, v238, v230, -v222
    v_fma_f32 v207, v238, v215, -v207
    v_fma_f32 v223, v238, v231, -v223
    v_fma_f32 v208, v238, v216, -v208
    v_fma_f32 v224, v238, v232, -v224
    v_fma_f32 v209, v238, v217, -v209
    v_fma_f32 v225, v238, v233, -v225
    v_cvt_pk_bf16_f32 v76, v202, v203
    v_cvt_pk_bf16_f32 v104, v218, v219
    v_cvt_pk_bf16_f32 v77, v204, v205
    v_cvt_pk_bf16_f32 v105, v220, v221
    v_cvt_pk_bf16_f32 v78, v206, v207
    v_cvt_pk_bf16_f32 v106, v222, v223
    v_cvt_pk_bf16_f32 v79, v208, v209
    v_cvt_pk_bf16_f32 v107, v224, v225
    s_mov_b32 s61, 128
    s_mov_b32 s60, 0
    s_waitcnt vmcnt(0)
    s_cmp_lg_u32 s3, 0
    s_cbranch_scc1 SY1_JOIN
SY1_POLL:
    v_cmp_eq_u32 vcc, 0, v192
    v_cmp_ne_u32 s[62:63], 32, v196
    s_nop 1
    s_and_b64 s[62:63], s[62:63], 0xff
    s_or_b64 vcc, vcc, s[62:63]
    s_cmp_eq_u64 vcc, 0
    s_cbranch_scc1 SY1_JOIN
    s_add_u32 s60, s60, 1
    s_cmp_ge_u32 s60, 0x40000
    s_cbranch_scc1 SY1_JOIN
    s_lshl_b32 s62, s90, 7
    s_add_u32 s62, s62, 98304
    buffer_load_dword v192, v200, s[56:59], s62 offen sc0 sc1
    v_lshrrev_b32 v197, 2, v200
    buffer_load_dword v196, v197, s[16:19], 0 offen sc0 sc1
    s_waitcnt vmcnt(0)
    s_branch SY1_POLL
    s_nop 7
    s_nop 3
SY1_JOIN:
    s_barrier
    s_add_u32 s16, s6, 0x200000
    s_addc_u32 s17, s7, 0
    s_mov_b32 s18, 0x200000
    s_mov_b32 s19, 0x00020000
    s_and_b32 s62, s3, 1
    s_lshl_b32 s62, s62, 15
    s_xor_b32 s63, s62, 0
    buffer_load_dword v128, v121, s[12:15], s63 offen offset:0 sc0 sc1
    buffer_load_dword v129, v121, s[12:15], s63 offen offset:1024 sc0 sc1
    buffer_load_dword v130, v121, s[12:15], s63 offen offset:2048 sc0 sc1
    buffer_load_dword v131, v121, s[12:15], s63 offen offset:3072 sc0 sc1
    s_xor_b32 s63, s62, 16384
    buffer_load_dword v132, v121, s[12:15], s63 offen offset:0 sc0 sc1
    buffer_load_dword v133, v121, s[12:15], s63 offen offset:1024 sc0 sc1
    buffer_load_dword v134, v121, s[12:15], s63 offen offset:2048 sc0 sc1
    buffer_load_dword v135, v121, s[12:15], s63 offen offset:3072 sc0 sc1
    s_xor_b32 s63, s62, 32768
    buffer_load_dword v136, v121, s[12:15], s63 offen offset:0 sc0 sc1
    buffer_load_dword v137, v121, s[12:15], s63 offen offset:1024 sc0 sc1
    buffer_load_dword v138, v121, s[12:15], s63 offen offset:2048 sc0 sc1
    buffer_load_dword v139, v121, s[12:15], s63 offen offset:3072 sc0 sc1
    s_xor_b32 s63, s62, 49152
    buffer_load_dword v140, v121, s[12:15], s63 offen offset:0 sc0 sc1
    buffer_load_dword v141, v121, s[12:15], s63 offen offset:1024 sc0 sc1
    buffer_load_dword v142, v121, s[12:15], s63 offen offset:2048 sc0 sc1
    buffer_load_dword v143, v121, s[12:15], s63 offen offset:3072 sc0 sc1
    s_mov_b32 s63, 0
    buffer_load_short_d16_hi v144, v122, s[28:31], s63 offen
    buffer_load_short_d16_hi v152, v122, s[32:35], s63 offen
    s_mov_b32 s63, 14400
    buffer_load_short_d16_hi v145, v122, s[28:31], s63 offen
    buffer_load_short_d16_hi v153, v122, s[32:35], s63 offen
    s_mov_b32 s63, 28800
    buffer_load_short_d16_hi v146, v122, s[28:31], s63 offen
    buffer_load_short_d16_hi v154, v122, s[32:35], s63 offen
    s_mov_b32 s63, 43200
    buffer_load_short_d16_hi v147, v122, s[28:31], s63 offen
    buffer_load_short_d16_hi v155, v122, s[32:35], s63 offen
    s_mov_b32 s63, 230400
    buffer_load_short_d16_hi v148, v122, s[28:31], s63 offen
    buffer_load_short_d16_hi v156, v122, s[32:35], s63 offen
    s_mov_b32 s63, 244800
    buffer_load_short_d16_hi v149, v122, s[28:31], s63 offen
    buffer_load_short_d16_hi v157, v122, s[32:35], s63 offen
    s_mov_b32 s63, 259200
    buffer_load_short_d16_hi v150, v122, s[28:31], s63 offen
    buffer_load_short_d16_hi v158, v122, s[32:35], s63 offen
    s_mov_b32 s63, 273600
    buffer_load_short_d16_hi v151, v122, s[28:31], s63 offen
    buffer_load_short_d16_hi v159, v122, s[32:35], s63 offen
    s_cmp_ge_u32 s89, 14
    s_cselect_b32 s63, 0x40000000, 0
    s_add_u32 s61, s63, 917504
    buffer_load_dwordx2 v[108:109], v125, s[8:11], s63 offen
    buffer_load_dwordx2 v[110:111], v126, s[8:11], s63 offen
    buffer_load_dwordx2 v[112:113], v125, s[8:11], s61 offen
    buffer_load_dwordx2 v[114:115], v126, s[8:11], s61 offen
    v_lshlrev_b32 v4, 6, v8
    v_add_u32 v4, s88, v4
    v_cvt_f32_u32 v192, v4
    v_add_f32 v193, 0x44800000, v192
    v_mov_b32 v194, 0x00000000
    v_fmac_f32 v194, 0x3b000000, v127
    v_mov_b32 v195, 0x3a000000
    v_fmac_f32 v195, 0x3b000000, v127
    v_mov_b32 v196, 0x3a800000
    v_fmac_f32 v196, 0x3b000000, v127
    v_mov_b32 v197, 0x3ac00000
    v_fmac_f32 v197, 0x3b000000, v127
    v_mov_b32 v198, 0x3c000000
    v_fmac_f32 v198, 0x3b000000, v127
    v_mov_b32 v199, 0x3c080000
    v_fmac_f32 v199, 0x3b000000, v127
    v_mov_b32 v200, 0x3c100000
    v_fmac_f32 v200, 0x3b000000, v127
    v_mov_b32 v201, 0x3c180000
    v_fmac_f32 v201, 0x3b000000, v127
    v_mul_f32 v202, v192, v194
    v_mul_f32 v203, v192, v195
    v_fract_f32 v202, v202
    v_fract_f32 v203, v203
    v_cos_f32 v204, v202
    v_cos_f32 v205, v203
    v_sin_f32 v206, v202
    v_sin_f32 v207, v203
    v_cvt_pk_bf16_f32 v20, v204, -v206
    v_cvt_pk_bf16_f32 v28, v206, v204
    v_cvt_pk_bf16_f32 v21, v205, -v207
    v_cvt_pk_bf16_f32 v29, v207, v205
    v_mul_f32 v202, v192, v196
    v_mul_f32 v203, v192, v197
    v_fract_f32 v202, v202
    v_fract_f32 v203, v203
    v_cos_f32 v204, v202
    v_cos_f32 v205, v203
    v_sin_f32 v206, v202
    v_sin_f32 v207, v203
    v_cvt_pk_bf16_f32 v22, v204, -v206
    v_cvt_pk_bf16_f32 v30, v206, v204
    v_cvt_pk_bf16_f32 v23, v205, -v207
    v_cvt_pk_bf16_f32 v31, v207, v205
    v_mul_f32 v202, v192, v198
    v_mul_f32 v203, v192, v199
    v_fract_f32 v202, v202
    v_fract_f32 v203, v203
    v_cos_f32 v204, v202
    v_cos_f32 v205, v203
    v_sin_f32 v206, v202
    v_sin_f32 v207, v203
    v_cvt_pk_bf16_f32 v24, v204, -v206
    v_cvt_pk_bf16_f32 v32, v206, v204
    v_cvt_pk_bf16_f32 v25, v205, -v207
    v_cvt_pk_bf16_f32 v33, v207, v205
    v_mul_f32 v202, v192, v200
    v_mul_f32 v203, v192, v201
    v_fract_f32 v202, v202
    v_fract_f32 v203, v203
    v_cos_f32 v204, v202
    v_cos_f32 v205, v203
    v_sin_f32 v206, v202
    v_sin_f32 v207, v203
    v_cvt_pk_bf16_f32 v26, v204, -v206
    v_cvt_pk_bf16_f32 v34, v206, v204
    v_cvt_pk_bf16_f32 v27, v205, -v207
    v_cvt_pk_bf16_f32 v35, v207, v205
    v_mul_f32 v202, v193, v194
    v_mul_f32 v203, v193, v195
    v_fract_f32 v202, v202
    v_fract_f32 v203, v203
    v_cos_f32 v204, v202
    v_cos_f32 v205, v203
    v_sin_f32 v206, v202
    v_sin_f32 v207, v203
    v_cvt_pk_bf16_f32 v36, v204, -v206
    v_cvt_pk_bf16_f32 v44, v206, v204
    v_cvt_pk_bf16_f32 v37, v205, -v207
    v_cvt_pk_bf16_f32 v45, v207, v205
    v_mul_f32 v202, v193, v196
    v_mul_f32 v203, v193, v197
    v_fract_f32 v202, v202
    v_fract_f32 v203, v203
    v_cos_f32 v204, v202
    v_cos_f32 v205, v203
    v_sin_f32 v206, v202
    v_sin_f32 v207, v203
    v_cvt_pk_bf16_f32 v38, v204, -v206
    v_cvt_pk_bf16_f32 v46, v206, v204
    v_cvt_pk_bf16_f32 v39, v205, -v207
    v_cvt_pk_bf16_f32 v47, v207, v205
    v_mul_f32 v202, v193, v198
    v_mul_f32 v203, v193, v199
    v_fract_f32 v202, v202
    v_fract_f32 v203, v203
    v_cos_f32 v204, v202
    v_cos_f32 v205, v203
    v_sin_f32 v206, v202
    v_sin_f32 v207, v203
    v_cvt_pk_bf16_f32 v40, v204, -v206
    v_cvt_pk_bf16_f32 v48, v206, v204
    v_cvt_pk_bf16_f32 v41, v205, -v207
    v_cvt_pk_bf16_f32 v49, v207, v205
    v_mul_f32 v202, v193, v200
    v_mul_f32 v203, v193, v201
    v_fract_f32 v202, v202
    v_fract_f32 v203, v203
    v_cos_f32 v204, v202
    v_cos_f32 v205, v203
    v_sin_f32 v206, v202
    v_sin_f32 v207, v203
    v_cvt_pk_bf16_f32 v42, v204, -v206
    v_cvt_pk_bf16_f32 v50, v206, v204
    v_cvt_pk_bf16_f32 v43, v205, -v207
    v_cvt_pk_bf16_f32 v51, v207, v205
    s_mov_b32 s90, 0x05040100
    s_mov_b32 s91, 0x07060302
    s_lshl_b32 s63, s3, 11
    v_add_u32 v216, s63, v12
    s_waitcnt vmcnt(20)
    v_perm_b32 v192, v129, v128, s90
    v_perm_b32 v200, v129, v128, s91
    v_perm_b32 v193, v131, v130, s90
    v_perm_b32 v201, v131, v130, s91
    v_perm_b32 v194, v133, v132, s90
    v_perm_b32 v202, v133, v132, s91
    v_perm_b32 v195, v135, v134, s90
    v_perm_b32 v203, v135, v134, s91
    v_perm_b32 v196, v137, v136, s90
    v_perm_b32 v204, v137, v136, s91
    v_perm_b32 v197, v139, v138, s90
    v_perm_b32 v205, v139, v138, s91
    v_perm_b32 v198, v141, v140, s90
    v_perm_b32 v206, v141, v140, s91
    v_perm_b32 v199, v143, v142, s90
    v_perm_b32 v207, v143, v142, s91
    v_xor_b32 v208, 0x80008000, v192
    v_xor_b32 v209, 0x80008000, v193
    v_xor_b32 v210, 0x80008000, v194
    v_xor_b32 v211, 0x80008000, v195
    v_xor_b32 v212, 0x80008000, v196
    v_xor_b32 v213, 0x80008000, v197
    v_xor_b32 v214, 0x80008000, v198
    v_xor_b32 v215, 0x80008000, v199
    v_mfma_f32_16x16x32_bf16 v[220:223], v[160:163], v[192:195], 0
    v_mfma_f32_16x16x32_bf16 v[228:231], v[160:163], v[200:203], 0
    s_add_u32 m0, s55, 16384
    s_mov_b32 s54, 458752
    buffer_load_dwordx4 v16, s[36:39], s54 offen lds
    v_mfma_f32_16x16x32_bf16 v[224:227], v[176:179], v[192:195], 0
    v_mfma_f32_16x16x32_bf16 v[232:235], v[176:179], v[200:203], 0
    s_add_u32 m0, s55, 17408
    s_mov_b32 s54, 458752
    buffer_load_dwordx4 v16, s[40:43], s54 offen lds
    v_mfma_f32_16x16x32_bf16 v[220:223], v[164:167], v[200:203], v[220:223]
    v_mfma_f32_16x16x32_bf16 v[228:231], v[164:167], v[208:211], v[228:231]
    s_add_u32 m0, s55, 18432
    s_mov_b32 s54, 516096
    buffer_load_dwordx4 v16, s[36:39], s54 offen lds
    v_mfma_f32_16x16x32_bf16 v[224:227], v[180:183], v[200:203], v[224:227]
    v_mfma_f32_16x16x32_bf16 v[232:235], v[180:183], v[208:211], v[232:235]
    s_add_u32 m0, s55, 19456
    s_mov_b32 s54, 516096
    buffer_load_dwordx4 v16, s[40:43], s54 offen lds
    v_mfma_f32_16x16x32_bf16 v[220:223], v[168:171], v[196:199], v[220:223]
    v_mfma_f32_16x16x32_bf16 v[228:231], v[168:171], v[204:207], v[228:231]
    s_add_u32 m0, s55, 20480
    s_mov_b32 s54, 573440
    buffer_load_dwordx4 v16, s[36:39], s54 offen lds
    v_mfma_f32_16x16x32_bf16 v[224:227], v[184:187], v[196:199], v[224:227]
    v_mfma_f32_16x16x32_bf16 v[232:235], v[184:187], v[204:207], v[232:235]
    s_add_u32 m0, s55, 21504
    s_mov_b32 s54, 573440
    buffer_load_dwordx4 v16, s[40:43], s54 offen lds
    v_mfma_f32_16x16x32_bf16 v[220:223], v[172:175], v[204:207], v[220:223]
    v_mfma_f32_16x16x32_bf16 v[228:231], v[172:175], v[212:215], v[228:231]
    s_add_u32 m0, s55, 22528
    s_mov_b32 s54, 630784
    buffer_load_dwordx4 v16, s[36:39], s54 offen lds
    v_mfma_f32_16x16x32_bf16 v[224:227], v[188:191], v[204:207], v[224:227]
    v_mfma_f32_16x16x32_bf16 v[232:235], v[188:191], v[212:215], v[232:235]
    s_add_u32 m0, s55, 23552
    s_mov_b32 s54, 630784
    buffer_load_dwordx4 v16, s[40:43], s54 offen lds
    s_add_u32 m0, s55, 24576
    s_mov_b32 s54, 688128
    buffer_load_dwordx4 v16, s[36:39], s54 offen lds
    s_add_u32 m0, s55, 25600
    s_mov_b32 s54, 688128
    buffer_load_dwordx4 v16, s[40:43], s54 offen lds
    s_waitcnt vmcnt(14)
    v_mul_f32 v144, v144, v124
    v_mul_f32 v152, v152, v124
    v_mul_f32 v145, v145, v124
    v_mul_f32 v153, v153, v124
    v_mul_f32 v146, v146, v124
    v_mul_f32 v154, v154, v124
    v_mul_f32 v147, v147, v124
    v_mul_f32 v155, v155, v124
    v_mul_f32 v148, v148, v124
    v_mul_f32 v156, v156, v124
    v_mul_f32 v149, v149, v124
    v_mul_f32 v157, v157, v124
    v_mul_f32 v150, v150, v124
    v_mul_f32 v158, v158, v124
    v_mul_f32 v151, v151, v124
    v_mul_f32 v159, v159, v124
    s_waitcnt vmcnt(63)
    ds_read_b64_tr_b16 v[236:237], v18 offset:28672
    ds_read_b64_tr_b16 v[238:239], v18 offset:29184
    ds_read_b64_tr_b16 v[240:241], v18 offset:29696
    ds_read_b64_tr_b16 v[242:243], v18 offset:30208
    v_mul_f32 v128, v220, v144
    v_mul_f32 v136, v220, v152
    v_mul_f32 v129, v221, v145
    v_mul_f32 v137, v221, v153
    v_mul_f32 v130, v222, v146
    v_mul_f32 v138, v222, v154
    v_mul_f32 v131, v223, v147
    v_mul_f32 v139, v223, v155
    v_mul_f32 v132, v224, v148
    v_mul_f32 v140, v224, v156
    v_mul_f32 v133, v225, v149
    v_mul_f32 v141, v225, v157
    v_mul_f32 v134, v226, v150
    v_mul_f32 v142, v226, v158
    v_mul_f32 v135, v227, v151
    v_mul_f32 v143, v227, v159
    v_fma_f32 v128, -v228, v152, v128
    v_fma_f32 v136, v228, v144, v136
    v_fma_f32 v129, -v229, v153, v129
    v_fma_f32 v137, v229, v145, v137
    v_fma_f32 v130, -v230, v154, v130
    v_fma_f32 v138, v230, v146, v138
    v_fma_f32 v131, -v231, v155, v131
    v_fma_f32 v139, v231, v147, v139
    v_fma_f32 v132, -v232, v156, v132
    v_fma_f32 v140, v232, v148, v140
    v_fma_f32 v133, -v233, v157, v133
    v_fma_f32 v141, v233, v149, v141
    v_fma_f32 v134, -v234, v158, v134
    v_fma_f32 v142, v234, v150, v142
    v_fma_f32 v135, -v235, v159, v135
    v_fma_f32 v143, v235, v151, v143
    v_cvt_pk_bf16_f32 v192, v128, v129
    v_cvt_pk_bf16_f32 v200, v136, v137
    v_cvt_pk_bf16_f32 v193, v130, v131
    v_cvt_pk_bf16_f32 v201, v138, v139
    v_cvt_pk_bf16_f32 v194, v132, v133
    v_cvt_pk_bf16_f32 v202, v140, v141
    v_cvt_pk_bf16_f32 v195, v134, v135
    v_cvt_pk_bf16_f32 v203, v142, v143
    ds_write_b128 v216, v[192:195]
    ds_write_b128 v216, v[200:203] offset:1024
    v_xor_b32 v208, 0x80008000, v200
    v_xor_b32 v209, 0x80008000, v201
    v_xor_b32 v210, 0x80008000, v202
    v_xor_b32 v211, 0x80008000, v203
    v_xor_b32 v216, 0x800, v216
    s_waitcnt lgkmcnt(0)
    s_barrier
    buffer_store_dwordx4 v[236:239], v12, s[44:47], s92 offen sc0 sc1
    buffer_store_dwordx4 v[240:243], v12, s[44:47], s93 offen sc0 sc1
    ds_read_b128 v[196:199], v216
    ds_read_b128 v[204:207], v216 offset:1024
    v_mfma_f32_16x16x32_bf16 v[220:223], v[160:163], v[192:195], 0
    v_mfma_f32_16x16x32_bf16 v[228:231], v[160:163], v[200:203], 0
    v_mfma_f32_16x16x32_bf16 v[224:227], v[176:179], v[192:195], 0
    v_mfma_f32_16x16x32_bf16 v[232:235], v[176:179], v[200:203], 0
    v_mfma_f32_16x16x32_bf16 v[220:223], v[164:167], v[208:211], v[220:223]
    v_mfma_f32_16x16x32_bf16 v[228:231], v[164:167], v[192:195], v[228:231]
    v_mfma_f32_16x16x32_bf16 v[224:227], v[180:183], v[208:211], v[224:227]
    v_mfma_f32_16x16x32_bf16 v[232:235], v[180:183], v[192:195], v[232:235]
    s_waitcnt lgkmcnt(0)
    v_xor_b32 v212, 0x80008000, v204
    v_xor_b32 v213, 0x80008000, v205
    v_xor_b32 v214, 0x80008000, v206
    v_xor_b32 v215, 0x80008000, v207
    v_mfma_f32_16x16x32_bf16 v[220:223], v[168:171], v[196:199], v[220:223]
    v_mfma_f32_16x16x32_bf16 v[228:231], v[168:171], v[204:207], v[228:231]
    v_mfma_f32_16x16x32_bf16 v[224:227], v[184:187], v[196:199], v[224:227]
    v_mfma_f32_16x16x32_bf16 v[232:235], v[184:187], v[204:207], v[232:235]
    v_mfma_f32_16x16x32_bf16 v[220:223], v[172:175], v[212:215], v[220:223]
    v_mfma_f32_16x16x32_bf16 v[228:231], v[172:175], v[196:199], v[228:231]
    v_mfma_f32_16x16x32_bf16 v[224:227], v[188:191], v[212:215], v[224:227]
    v_mfma_f32_16x16x32_bf16 v[232:235], v[188:191], v[196:199], v[232:235]
    s_nop 5
    v_cvt_pk_bf16_f32 v128, v220, v228
    v_cvt_pk_bf16_f32 v129, v221, v229
    v_cvt_pk_bf16_f32 v130, v222, v230
    v_cvt_pk_bf16_f32 v131, v223, v231
    v_cvt_pk_bf16_f32 v132, v224, v232
    v_cvt_pk_bf16_f32 v133, v225, v233
    v_cvt_pk_bf16_f32 v134, v226, v234
    v_cvt_pk_bf16_f32 v135, v227, v235
    s_mov_b32 vcc_lo, 0x55555555
    s_mov_b32 vcc_hi, 0x55555555
    v_cndmask_b32_dpp v136, v129, v128, vcc quad_perm:[1,0,3,2] row_mask:0xf bank_mask:0xf
    v_cndmask_b32_dpp v138, v131, v130, vcc quad_perm:[1,0,3,2] row_mask:0xf bank_mask:0xf
    v_cndmask_b32_dpp v140, v133, v132, vcc quad_perm:[1,0,3,2] row_mask:0xf bank_mask:0xf
    v_cndmask_b32_dpp v142, v135, v134, vcc quad_perm:[1,0,3,2] row_mask:0xf bank_mask:0xf
    s_mov_b32 vcc_lo, 0xaaaaaaaa
    s_mov_b32 vcc_hi, 0xaaaaaaaa
    v_cndmask_b32_dpp v137, v128, v129, vcc quad_perm:[1,0,3,2] row_mask:0xf bank_mask:0xf
    v_cndmask_b32_dpp v139, v130, v131, vcc quad_perm:[1,0,3,2] row_mask:0xf bank_mask:0xf
    v_cndmask_b32_dpp v141, v132, v133, vcc quad_perm:[1,0,3,2] row_mask:0xf bank_mask:0xf
    v_cndmask_b32_dpp v143, v134, v135, vcc quad_perm:[1,0,3,2] row_mask:0xf bank_mask:0xf
    s_mov_b32 vcc_lo, 0x33333333
    s_mov_b32 vcc_hi, 0x33333333
    v_cndmask_b32_dpp v128, v138, v136, vcc quad_perm:[2,3,0,1] row_mask:0xf bank_mask:0xf
    v_cndmask_b32_dpp v129, v139, v137, vcc quad_perm:[2,3,0,1] row_mask:0xf bank_mask:0xf
    v_cndmask_b32_dpp v132, v142, v140, vcc quad_perm:[2,3,0,1] row_mask:0xf bank_mask:0xf
    v_cndmask_b32_dpp v133, v143, v141, vcc quad_perm:[2,3,0,1] row_mask:0xf bank_mask:0xf
    s_mov_b32 vcc_lo, 0xcccccccc
    s_mov_b32 vcc_hi, 0xcccccccc
    v_cndmask_b32_dpp v130, v136, v138, vcc quad_perm:[2,3,0,1] row_mask:0xf bank_mask:0xf
    v_cndmask_b32_dpp v131, v137, v139, vcc quad_perm:[2,3,0,1] row_mask:0xf bank_mask:0xf
    v_cndmask_b32_dpp v134, v140, v142, vcc quad_perm:[2,3,0,1] row_mask:0xf bank_mask:0xf
    v_cndmask_b32_dpp v135, v141, v143, vcc quad_perm:[2,3,0,1] row_mask:0xf bank_mask:0xf
    s_mov_b32 s63, 0x80000
    buffer_store_dwordx4 v[128:131], v123, s[16:19], 0 offen sc0 sc1
    buffer_store_dwordx4 v[132:135], v123, s[16:19], s63 offen sc0 sc1
    s_lshl_b32 s60, s2, 7
    s_add_u32 s60, s60, 0
    v_mov_b32 v4, 1
    v_lshlrev_b32 v5, 20, v0
    v_lshlrev_b32 v124, 7, v0
    v_and_b32 v6, 0xffffe000, v124
    v_lshl_add_u32 v124, v6, 12, v124
    s_waitcnt vmcnt(0)
    s_barrier
    buffer_store_dword v4, v5, s[56:59], s60 offen sc0 sc1
    s_mov_b32 s91, 0xc4600000
    v_cvt_f32_u32 v126, v9
    s_lshl_b32 s62, s89, 5
    v_lshl_add_u32 v125, v8, 1, s62
    v_add_u32 v125, 1, v125
    v_cvt_f32_u32 v125, v125
    v_mov_b32 v128, 0x3f803f80
    v_mov_b32 v129, 0x3f803f80
    v_mov_b32 v130, 0x3f803f80
    v_mov_b32 v131, 0x3f803f80
    ds_read_b64_tr_b16 a[0:1], v17 offset:0
    ds_read_b64_tr_b16 a[2:3], v17 offset:256
    ds_read_b64_tr_b16 a[4:5], v17 offset:1024
    ds_read_b64_tr_b16 a[6:7], v17 offset:1280
    ds_read_b64_tr_b16 a[8:9], v17 offset:2048
    ds_read_b64_tr_b16 a[10:11], v17 offset:2304
    ds_read_b64_tr_b16 a[12:13], v17 offset:3072
    ds_read_b64_tr_b16 a[14:15], v17 offset:3328
    ds_read_b64_tr_b16 a[16:17], v17 offset:4096
    ds_read_b64_tr_b16 a[18:19], v17 offset:4352
    ds_read_b64_tr_b16 a[20:21], v17 offset:5120
    ds_read_b64_tr_b16 a[22:23], v17 offset:5376
    ds_read_b64_tr_b16 a[24:25], v17 offset:6144
    ds_read_b64_tr_b16 a[26:27], v17 offset:6400
    ds_read_b64_tr_b16 a[28:29], v17 offset:7168
    ds_read_b64_tr_b16 a[30:31], v17 offset:7424
    ds_read_b64_tr_b16 a[32:33], v17 offset:8192
    ds_read_b64_tr_b16 a[34:35], v17 offset:8448
    ds_read_b64_tr_b16 a[36:37], v17 offset:9216
    ds_read_b64_tr_b16 a[38:39], v17 offset:9472
    ds_read_b64_tr_b16 a[40:41], v17 offset:10240
    ds_read_b64_tr_b16 a[42:43], v17 offset:10496
    ds_read_b64_tr_b16 a[44:45], v17 offset:11264
    ds_read_b64_tr_b16 a[46:47], v17 offset:11520
    ds_read_b64_tr_b16 a[48:49], v17 offset:12288
    ds_read_b64_tr_b16 a[50:51], v17 offset:12544
    ds_read_b64_tr_b16 a[52:53], v17 offset:13312
    ds_read_b64_tr_b16 a[54:55], v17 offset:13568
    ds_read_b64_tr_b16 a[56:57], v17 offset:14336
    ds_read_b64_tr_b16 a[58:59], v17 offset:14592
    ds_read_b64_tr_b16 a[60:61], v17 offset:15360
    ds_read_b64_tr_b16 a[62:63], v17 offset:15616
    ds_read_b64_tr_b16 a[64:65], v17 offset:16384
    ds_read_b64_tr_b16 a[66:67], v17 offset:16640
    ds_read_b64_tr_b16 a[68:69], v17 offset:17408
    ds_read_b64_tr_b16 a[70:71], v17 offset:17664
    ds_read_b64_tr_b16 a[72:73], v17 offset:18432
    ds_read_b64_tr_b16 a[74:75], v17 offset:18688
    ds_read_b64_tr_b16 a[76:77], v17 offset:19456
    ds_read_b64_tr_b16 a[78:79], v17 offset:19712
    ds_read_b64_tr_b16 a[80:81], v17 offset:20480
    ds_read_b64_tr_b16 a[82:83], v17 offset:20736
    ds_read_b64_tr_b16 a[84:85], v17 offset:21504
    ds_read_b64_tr_b16 a[86:87], v17 offset:21760
    ds_read_b64_tr_b16 a[88:89], v17 offset:22528
    ds_read_b64_tr_b16 a[90:91], v17 offset:22784
    ds_read_b64_tr_b16 a[92:93], v17 offset:23552
    ds_read_b64_tr_b16 a[94:95], v17 offset:23808
    ds_read_b64_tr_b16 a[96:97], v17 offset:24576
    ds_read_b64_tr_b16 a[98:99], v17 offset:24832
    ds_read_b64_tr_b16 a[100:101], v17 offset:25600
    ds_read_b64_tr_b16 a[102:103], v17 offset:25856
    s_waitcnt lgkmcnt(0)
    s_add_u32 m0, s55, 0
    s_mov_b32 s54, 745472
    buffer_load_dwordx4 v16, s[36:39], s54 offen lds
    v_mfma_f32_32x32x16_bf16 v[132:147], v[128:131], a[0:3], 0
    s_add_u32 m0, s55, 1024
    s_mov_b32 s54, 745472
    buffer_load_dwordx4 v16, s[40:43], s54 offen lds
    v_mfma_f32_32x32x16_bf16 v[148:163], v[128:131], a[4:7], 0
    s_add_u32 m0, s55, 2048
    s_mov_b32 s54, 802816
    buffer_load_dwordx4 v16, s[36:39], s54 offen lds
    v_mfma_f32_32x32x16_bf16 v[132:147], v[128:131], a[8:11], v[132:147]
    s_add_u32 m0, s55, 3072
    s_mov_b32 s54, 802816
    buffer_load_dwordx4 v16, s[40:43], s54 offen lds
    v_mfma_f32_32x32x16_bf16 v[148:163], v[128:131], a[12:15], v[148:163]
    s_add_u32 m0, s55, 4096
    s_mov_b32 s54, 860160
    buffer_load_dwordx4 v16, s[36:39], s54 offen lds
    v_mfma_f32_32x32x16_bf16 v[132:147], v[128:131], a[16:19], v[132:147]
    s_add_u32 m0, s55, 5120
    s_mov_b32 s54, 860160
    buffer_load_dwordx4 v16, s[40:43], s54 offen lds
    v_mfma_f32_32x32x16_bf16 v[148:163], v[128:131], a[20:23], v[148:163]
    s_add_u32 m0, s55, 6144
    s_mov_b32 s54, 917504
    buffer_load_dwordx4 v16, s[36:39], s54 offen lds
    v_mfma_f32_32x32x16_bf16 v[132:147], v[128:131], a[24:27], v[132:147]
    s_add_u32 m0, s55, 7168
    s_mov_b32 s54, 917504
    buffer_load_dwordx4 v16, s[40:43], s54 offen lds
    v_mfma_f32_32x32x16_bf16 v[148:163], v[128:131], a[28:31], v[148:163]
    s_add_u32 m0, s55, 8192
    s_mov_b32 s54, 974848
    buffer_load_dwordx4 v16, s[36:39], s54 offen lds
    v_mfma_f32_32x32x16_bf16 v[132:147], v[128:131], a[32:35], v[132:147]
    s_add_u32 m0, s55, 9216
    s_mov_b32 s54, 974848
    buffer_load_dwordx4 v16, s[40:43], s54 offen lds
    v_mfma_f32_32x32x16_bf16 v[148:163], v[128:131], a[36:39], v[148:163]
    s_add_u32 m0, s55, 10240
    s_mov_b32 s54, 1032192
    buffer_load_dwordx4 v16, s[36:39], s54 offen lds
    v_mfma_f32_32x32x16_bf16 v[132:147], v[128:131], a[40:43], v[132:147]
    s_add_u32 m0, s55, 11264
    s_mov_b32 s54, 1032192
    buffer_load_dwordx4 v16, s[40:43], s54 offen lds
    v_mfma_f32_32x32x16_bf16 v[148:163], v[128:131], a[44:47], v[148:163]
    s_add_u32 m0, s55, 12288
    s_mov_b32 s54, 1089536
    buffer_load_dwordx4 v16, s[36:39], s54 offen lds
    v_mfma_f32_32x32x16_bf16 v[132:147], v[128:131], a[48:51], v[132:147]
    s_add_u32 m0, s55, 13312
    s_mov_b32 s54, 1089536
    buffer_load_dwordx4 v16, s[40:43], s54 offen lds
    v_mfma_f32_32x32x16_bf16 v[148:163], v[128:131], a[52:55], v[148:163]
    s_add_u32 m0, s55, 14336
    s_mov_b32 s54, 1146880
    buffer_load_dwordx4 v16, s[36:39], s54 offen lds
    v_mfma_f32_32x32x16_bf16 v[132:147], v[128:131], a[56:59], v[132:147]
    s_add_u32 m0, s55, 15360
    s_mov_b32 s54, 1146880
    buffer_load_dwordx4 v16, s[40:43], s54 offen lds
    v_mfma_f32_32x32x16_bf16 v[148:163], v[128:131], a[60:63], v[148:163]
    s_add_u32 m0, s55, 16384
    s_mov_b32 s54, 1204224
    buffer_load_dwordx4 v16, s[36:39], s54 offen lds
    v_mfma_f32_32x32x16_bf16 v[132:147], v[128:131], a[64:67], v[132:147]
    s_add_u32 m0, s55, 17408
    s_mov_b32 s54, 1204224
    buffer_load_dwordx4 v16, s[40:43], s54 offen lds
    v_mfma_f32_32x32x16_bf16 v[148:163], v[128:131], a[68:71], v[148:163]
    v_mfma_f32_32x32x16_bf16 v[132:147], v[128:131], a[72:75], v[132:147]
    v_mfma_f32_32x32x16_bf16 v[148:163], v[128:131], a[76:79], v[148:163]
    v_mfma_f32_32x32x16_bf16 v[132:147], v[128:131], a[80:83], v[132:147]
    v_mfma_f32_32x32x16_bf16 v[148:163], v[128:131], a[84:87], v[148:163]
    v_mfma_f32_32x32x16_bf16 v[132:147], v[128:131], a[88:91], v[132:147]
    v_mfma_f32_32x32x16_bf16 v[148:163], v[128:131], a[92:95], v[148:163]
    v_mfma_f32_32x32x16_bf16 v[132:147], v[128:131], a[96:99], v[132:147]
    v_mfma_f32_32x32x16_bf16 v[148:163], v[128:131], a[100:103], v[148:163]
    s_mov_b32 s62, 0
    buffer_load_dword v120, v124, s[56:59], s62 offen sc0 sc1
    s_mov_b32 s62, 8192
    buffer_load_dword v121, v124, s[56:59], s62 offen sc0 sc1
    s_mov_b32 s62, 16384
    buffer_load_dword v122, v124, s[56:59], s62 offen sc0 sc1
    s_mov_b32 s62, 24576
    buffer_load_dword v123, v124, s[56:59], s62 offen sc0 sc1
    s_nop 2
    v_mov_b32 v118, v132
    v_mov_b32 v119, v148
    s_mov_b32 s61, 128
    s_mov_b32 s60, 0
    s_waitcnt vmcnt(0)
    s_cmp_lg_u32 s3, 0
    s_cbranch_scc1 SY2_JOIN
SY2_POLL:
    v_min_u32 v120, v120, v121
    v_min_u32 v122, v122, v123
    v_min_u32 v120, v120, v122
    v_cmp_eq_u32 vcc, 0, v120
    s_nop 1
    s_cmp_eq_u64 vcc, 0
    s_cbranch_scc1 SY2_JOIN
    s_add_u32 s60, s60, 1
    s_cmp_ge_u32 s60, 0x40000
    s_cbranch_scc1 SY2_JOIN
    s_mov_b32 s62, 0
    buffer_load_dword v120, v124, s[56:59], s62 offen sc0 sc1
    s_mov_b32 s62, 8192
    buffer_load_dword v121, v124, s[56:59], s62 offen sc0 sc1
    s_mov_b32 s62, 16384
    buffer_load_dword v122, v124, s[56:59], s62 offen sc0 sc1
    s_mov_b32 s62, 24576
    buffer_load_dword v123, v124, s[56:59], s62 offen sc0 sc1
    s_waitcnt vmcnt(0)
    s_branch SY2_POLL
    s_nop 7
    s_nop 3
SY2_JOIN:
    s_barrier
    s_lshl_b32 s60, s88, 15
    s_lshl_b32 s61, s3, 6
    s_add_u32 s60, s60, s61
    v_lshlrev_b32 v120, 12, v9
    v_lshl_add_u32 v120, v8, 2, v120
    v_add_u32 v120, s60, v120
    s_mov_b32 s63, 0
    buffer_load_dword v124, v120, s[16:19], s63 offen offset:0 sc0 sc1
    buffer_load_dword v125, v120, s[16:19], s63 offen offset:1024 sc0 sc1
    buffer_load_dword v126, v120, s[16:19], s63 offen offset:2048 sc0 sc1
    buffer_load_dword v127, v120, s[16:19], s63 offen offset:3072 sc0 sc1
    s_mov_b32 s63, 16384
    buffer_load_dword v128, v120, s[16:19], s63 offen offset:0 sc0 sc1
    buffer_load_dword v129, v120, s[16:19], s63 offen offset:1024 sc0 sc1
    buffer_load_dword v130, v120, s[16:19], s63 offen offset:2048 sc0 sc1
    buffer_load_dword v131, v120, s[16:19], s63 offen offset:3072 sc0 sc1
    s_mov_b32 s63, 256
    buffer_load_dword v132, v120, s[16:19], s63 offen offset:0 sc0 sc1
    buffer_load_dword v133, v120, s[16:19], s63 offen offset:1024 sc0 sc1
    buffer_load_dword v134, v120, s[16:19], s63 offen offset:2048 sc0 sc1
    buffer_load_dword v135, v120, s[16:19], s63 offen offset:3072 sc0 sc1
    s_mov_b32 s63, 16640
    buffer_load_dword v136, v120, s[16:19], s63 offen offset:0 sc0 sc1
    buffer_load_dword v137, v120, s[16:19], s63 offen offset:1024 sc0 sc1
    buffer_load_dword v138, v120, s[16:19], s63 offen offset:2048 sc0 sc1
    buffer_load_dword v139, v120, s[16:19], s63 offen offset:3072 sc0 sc1
    s_mov_b32 s63, 512
    buffer_load_dword v140, v120, s[16:19], s63 offen offset:0 sc0 sc1
    buffer_load_dword v141, v120, s[16:19], s63 offen offset:1024 sc0 sc1
    buffer_load_dword v142, v120, s[16:19], s63 offen offset:2048 sc0 sc1
    buffer_load_dword v143, v120, s[16:19], s63 offen offset:3072 sc0 sc1
    s_mov_b32 s63, 16896
    buffer_load_dword v144, v120, s[16:19], s63 offen offset:0 sc0 sc1
    buffer_load_dword v145, v120, s[16:19], s63 offen offset:1024 sc0 sc1
    buffer_load_dword v146, v120, s[16:19], s63 offen offset:2048 sc0 sc1
    buffer_load_dword v147, v120, s[16:19], s63 offen offset:3072 sc0 sc1
    s_mov_b32 s63, 768
    s_cmp_eq_u32 s3, 3
    s_cselect_b32 s63, 0x40000000, s63
    buffer_load_dword v148, v120, s[16:19], s63 offen offset:0 sc0 sc1
    buffer_load_dword v149, v120, s[16:19], s63 offen offset:1024 sc0 sc1
    buffer_load_dword v150, v120, s[16:19], s63 offen offset:2048 sc0 sc1
    buffer_load_dword v151, v120, s[16:19], s63 offen offset:3072 sc0 sc1
    s_mov_b32 s63, 17152
    s_cmp_eq_u32 s3, 3
    s_cselect_b32 s63, 0x40000000, s63
    buffer_load_dword v152, v120, s[16:19], s63 offen offset:0 sc0 sc1
    buffer_load_dword v153, v120, s[16:19], s63 offen offset:1024 sc0 sc1
    buffer_load_dword v154, v120, s[16:19], s63 offen offset:2048 sc0 sc1
    buffer_load_dword v155, v120, s[16:19], s63 offen offset:3072 sc0 sc1
    v_mul_u32_u24 v156, 544, v8
    v_lshl_add_u32 v156, v9, 3, v156
    s_lshl_b32 s63, s3, 5
    v_add_u32 v156, s63, v156
    s_waitcnt vmcnt(24)
    v_mfma_f32_16x16x32_bf16 v[160:163], v[124:127], v[20:23], 0
    v_mfma_f32_16x16x32_bf16 v[164:167], v[124:127], v[28:31], 0
    v_mfma_f32_16x16x32_bf16 v[168:171], v[124:127], v[36:39], 0
    v_mfma_f32_16x16x32_bf16 v[172:175], v[124:127], v[44:47], 0
    v_mfma_f32_16x16x32_bf16 v[160:163], v[128:131], v[24:27], v[160:163]
    v_mfma_f32_16x16x32_bf16 v[164:167], v[128:131], v[32:35], v[164:167]
    v_mfma_f32_16x16x32_bf16 v[168:171], v[128:131], v[40:43], v[168:171]
    v_mfma_f32_16x16x32_bf16 v[172:175], v[128:131], v[48:51], v[172:175]
    s_waitcnt vmcnt(16)
    v_mfma_f32_16x16x32_bf16 v[176:179], v[132:135], v[20:23], 0
    v_mfma_f32_16x16x32_bf16 v[180:183], v[132:135], v[28:31], 0
    v_mfma_f32_16x16x32_bf16 v[184:187], v[132:135], v[36:39], 0
    v_mfma_f32_16x16x32_bf16 v[188:191], v[132:135], v[44:47], 0
    v_mfma_f32_16x16x32_bf16 v[176:179], v[136:139], v[24:27], v[176:179]
    v_mfma_f32_16x16x32_bf16 v[180:183], v[136:139], v[32:35], v[180:183]
    v_mfma_f32_16x16x32_bf16 v[184:187], v[136:139], v[40:43], v[184:187]
    v_mfma_f32_16x16x32_bf16 v[188:191], v[136:139], v[48:51], v[188:191]
    v_cvt_pk_bf16_f32 v192, v160, v161
    v_cvt_pk_bf16_f32 v193, v162, v163
    ds_write_b64 v156, v[192:193] offset:0
    v_cvt_pk_bf16_f32 v194, v164, v165
    v_cvt_pk_bf16_f32 v195, v166, v167
    ds_write_b64 v156, v[194:195] offset:17408
    v_cvt_pk_bf16_f32 v196, v168, v169
    v_cvt_pk_bf16_f32 v197, v170, v171
    ds_write_b64 v156, v[196:197] offset:8704
    v_cvt_pk_bf16_f32 v198, v172, v173
    v_cvt_pk_bf16_f32 v199, v174, v175
    ds_write_b64 v156, v[198:199] offset:26112
    s_waitcnt vmcnt(8)
    v_mfma_f32_16x16x32_bf16 v[160:163], v[140:143], v[20:23], 0
    v_mfma_f32_16x16x32_bf16 v[164:167], v[140:143], v[28:31], 0
    v_mfma_f32_16x16x32_bf16 v[168:171], v[140:143], v[36:39], 0
    v_mfma_f32_16x16x32_bf16 v[172:175], v[140:143], v[44:47], 0
    v_mfma_f32_16x16x32_bf16 v[160:163], v[144:147], v[24:27], v[160:163]
    v_mfma_f32_16x16x32_bf16 v[164:167], v[144:147], v[32:35], v[164:167]
    v_mfma_f32_16x16x32_bf16 v[168:171], v[144:147], v[40:43], v[168:171]
    v_mfma_f32_16x16x32_bf16 v[172:175], v[144:147], v[48:51], v[172:175]
    v_cvt_pk_bf16_f32 v200, v176, v177
    v_cvt_pk_bf16_f32 v201, v178, v179
    ds_write_b64 v156, v[200:201] offset:128
    v_cvt_pk_bf16_f32 v202, v180, v181
    v_cvt_pk_bf16_f32 v203, v182, v183
    ds_write_b64 v156, v[202:203] offset:17536
    v_cvt_pk_bf16_f32 v204, v184, v185
    v_cvt_pk_bf16_f32 v205, v186, v187
    ds_write_b64 v156, v[204:205] offset:8832
    v_cvt_pk_bf16_f32 v206, v188, v189
    v_cvt_pk_bf16_f32 v207, v190, v191
    ds_write_b64 v156, v[206:207] offset:26240
    s_waitcnt vmcnt(0)
    v_mfma_f32_16x16x32_bf16 v[176:179], v[148:151], v[20:23], 0
    v_mfma_f32_16x16x32_bf16 v[180:183], v[148:151], v[28:31], 0
    s_add_u32 m0, s55, 18432
    s_mov_b32 s54, 1261568
    buffer_load_dwordx4 v16, s[36:39], s54 offen lds
    v_mfma_f32_16x16x32_bf16 v[184:187], v[148:151], v[36:39], 0
    v_mfma_f32_16x16x32_bf16 v[188:191], v[148:151], v[44:47], 0
    s_add_u32 m0, s55, 19456
    s_mov_b32 s54, 1261568
    buffer_load_dwordx4 v16, s[40:43], s54 offen lds
    v_mfma_f32_16x16x32_bf16 v[176:179], v[152:155], v[24:27], v[176:179]
    v_mfma_f32_16x16x32_bf16 v[180:183], v[152:155], v[32:35], v[180:183]
    s_add_u32 m0, s55, 20480
    s_mov_b32 s54, 1318912
    buffer_load_dwordx4 v16, s[36:39], s54 offen lds
    v_mfma_f32_16x16x32_bf16 v[184:187], v[152:155], v[40:43], v[184:187]
    v_mfma_f32_16x16x32_bf16 v[188:191], v[152:155], v[48:51], v[188:191]
    s_add_u32 m0, s55, 21504
    s_mov_b32 s54, 1318912
    buffer_load_dwordx4 v16, s[40:43], s54 offen lds
    v_cvt_pk_bf16_f32 v192, v160, v161
    v_cvt_pk_bf16_f32 v193, v162, v163
    ds_write_b64 v156, v[192:193] offset:256
    v_cvt_pk_bf16_f32 v194, v164, v165
    v_cvt_pk_bf16_f32 v195, v166, v167
    ds_write_b64 v156, v[194:195] offset:17664
    v_cvt_pk_bf16_f32 v196, v168, v169
    v_cvt_pk_bf16_f32 v197, v170, v171
    ds_write_b64 v156, v[196:197] offset:8960
    v_cvt_pk_bf16_f32 v198, v172, v173
    v_cvt_pk_bf16_f32 v199, v174, v175
    ds_write_b64 v156, v[198:199] offset:26368
    v_cvt_pk_bf16_f32 v200, v176, v177
    v_cvt_pk_bf16_f32 v201, v178, v179
    ds_write_b64 v156, v[200:201] offset:384
    v_cvt_pk_bf16_f32 v202, v180, v181
    v_cvt_pk_bf16_f32 v203, v182, v183
    ds_write_b64 v156, v[202:203] offset:17792
    v_cvt_pk_bf16_f32 v204, v184, v185
    v_cvt_pk_bf16_f32 v205, v186, v187
    ds_write_b64 v156, v[204:205] offset:9088
    v_cvt_pk_bf16_f32 v206, v188, v189
    v_cvt_pk_bf16_f32 v207, v190, v191
    ds_write_b64 v156, v[206:207] offset:26496
    s_waitcnt lgkmcnt(0)
    s_barrier
    v_mul_u32_u24 v157, 544, v8
    ds_read_u16 v158, v157 offset:17856
    ds_read_u16 v159, v157 offset:26560
    v_lshl_add_u32 v157, v9, 4, v157
    ds_read_b128 v[176:179], v157 offset:0
    ds_read_b128 v[180:183], v157 offset:8704
    ds_read_b128 v[184:187], v157 offset:17408
    ds_read_b128 v[188:191], v157 offset:26112
    ds_read_b128 v[192:195], v157 offset:64
    ds_read_b128 v[196:199], v157 offset:8768
    ds_read_b128 v[200:203], v157 offset:17472
    ds_read_b128 v[204:207], v157 offset:26176
    ds_read_b128 v[208:211], v157 offset:128
    ds_read_b128 v[212:215], v157 offset:8832
    ds_read_b128 v[216:219], v157 offset:17536
    ds_read_b128 v[220:223], v157 offset:26240
    v_lshlrev_b32 v124, 16, v108
    v_and_b32 v125, 0xffff0000, v108
    v_lshlrev_b32 v126, 16, v109
    v_and_b32 v127, 0xffff0000, v109
    v_lshlrev_b32 v128, 16, v110
    v_and_b32 v129, 0xffff0000, v110
    v_lshlrev_b32 v130, 16, v111
    v_and_b32 v131, 0xffff0000, v111
    v_lshlrev_b32 v132, 16, v112
    v_and_b32 v133, 0xffff0000, v112
    v_lshlrev_b32 v134, 16, v113
    v_and_b32 v135, 0xffff0000, v113
    v_lshlrev_b32 v136, 16, v114
    v_and_b32 v137, 0xffff0000, v114
    v_lshlrev_b32 v138, 16, v115
    v_and_b32 v139, 0xffff0000, v115
    s_waitcnt lgkmcnt(12)
    v_lshlrev_b32 v168, 16, v158
    v_xor_b32 v169, 0x80000000, v168
    v_mov_b32 v170, v168
    v_mov_b32 v171, v169
    v_lshlrev_b32 v172, 16, v159
    v_xor_b32 v173, 0x80000000, v172
    v_mov_b32 v174, v172
    v_mov_b32 v175, v173
    ds_read_b128 v[224:227], v157 offset:192
    ds_read_b128 v[228:231], v157 offset:8896
    ds_read_b128 v[232:235], v157 offset:17600
    ds_read_b128 v[236:239], v157 offset:26304
    s_waitcnt lgkmcnt(12)
    v_mfma_f32_16x16x32_bf16 v[160:163], v[52:55], v[176:179], 0
    v_mfma_f32_16x16x32_bf16 v[164:167], v[52:55], v[180:183], 0
    v_mfma_f32_16x16x32_bf16 v[168:171], v[80:83], v[184:187], v[168:171]
    v_mfma_f32_16x16x32_bf16 v[172:175], v[80:83], v[188:191], v[172:175]
    ds_read_b128 v[176:179], v157 offset:256
    ds_read_b128 v[180:183], v157 offset:8960
    ds_read_b128 v[184:187], v157 offset:17664
    ds_read_b128 v[188:191], v157 offset:26368
    s_add_u32 m0, s55, 22528
    s_mov_b32 s54, 1376256
    buffer_load_dwordx4 v16, s[36:39], s54 offen lds
    s_add_u32 m0, s55, 23552
    s_mov_b32 s54, 1376256
    buffer_load_dwordx4 v16, s[40:43], s54 offen lds
    s_waitcnt lgkmcnt(12)
    v_mfma_f32_16x16x32_bf16 v[160:163], v[56:59], v[192:195], v[160:163]
    v_mfma_f32_16x16x32_bf16 v[164:167], v[56:59], v[196:199], v[164:167]
    v_mfma_f32_16x16x32_bf16 v[168:171], v[84:87], v[200:203], v[168:171]
    v_mfma_f32_16x16x32_bf16 v[172:175], v[84:87], v[204:207], v[172:175]
    ds_read_b128 v[192:195], v157 offset:320
    ds_read_b128 v[196:199], v157 offset:9024
    ds_read_b128 v[200:203], v157 offset:17728
    ds_read_b128 v[204:207], v157 offset:26432
    s_add_u32 m0, s55, 24576
    s_mov_b32 s54, 1433600
    buffer_load_dwordx4 v16, s[36:39], s54 offen lds
    s_add_u32 m0, s55, 25600
    s_mov_b32 s54, 1433600
    buffer_load_dwordx4 v16, s[40:43], s54 offen lds
    s_waitcnt lgkmcnt(12)
    v_mfma_f32_16x16x32_bf16 v[160:163], v[60:63], v[208:211], v[160:163]
    v_mfma_f32_16x16x32_bf16 v[164:167], v[60:63], v[212:215], v[164:167]
    v_mfma_f32_16x16x32_bf16 v[168:171], v[88:91], v[216:219], v[168:171]
    v_mfma_f32_16x16x32_bf16 v[172:175], v[88:91], v[220:223], v[172:175]
    ds_read_b128 v[208:211], v157 offset:384
    ds_read_b128 v[212:215], v157 offset:9088
    ds_read_b128 v[216:219], v157 offset:17792
    ds_read_b128 v[220:223], v157 offset:26496
    s_add_u32 m0, s55, 26624
    s_mov_b32 s54, 1490944
    buffer_load_dwordx4 v16, s[36:39], s54 offen lds
    s_add_u32 m0, s55, 27648
    s_mov_b32 s54, 1490944
    buffer_load_dwordx4 v16, s[40:43], s54 offen lds
    s_waitcnt lgkmcnt(12)
    v_mfma_f32_16x16x32_bf16 v[160:163], v[64:67], v[224:227], v[160:163]
    v_mfma_f32_16x16x32_bf16 v[164:167], v[64:67], v[228:231], v[164:167]
    v_mfma_f32_16x16x32_bf16 v[168:171], v[92:95], v[232:235], v[168:171]
    v_mfma_f32_16x16x32_bf16 v[172:175], v[92:95], v[236:239], v[172:175]
    s_add_u32 m0, s55, 28672
    s_mov_b32 s54, 1548288
    buffer_load_dwordx4 v16, s[36:39], s54 offen lds
    s_add_u32 m0, s55, 29696
    s_mov_b32 s54, 1548288
    buffer_load_dwordx4 v16, s[40:43], s54 offen lds
    s_waitcnt lgkmcnt(8)
    v_mfma_f32_16x16x32_bf16 v[160:163], v[68:71], v[176:179], v[160:163]
    v_mfma_f32_16x16x32_bf16 v[164:167], v[68:71], v[180:183], v[164:167]
    v_mfma_f32_16x16x32_bf16 v[168:171], v[96:99], v[184:187], v[168:171]
    v_mfma_f32_16x16x32_bf16 v[172:175], v[96:99], v[188:191], v[172:175]
    s_waitcnt lgkmcnt(4)
    v_mfma_f32_16x16x32_bf16 v[160:163], v[72:75], v[192:195], v[160:163]
    v_mfma_f32_16x16x32_bf16 v[164:167], v[72:75], v[196:199], v[164:167]
    v_mfma_f32_16x16x32_bf16 v[168:171], v[100:103], v[200:203], v[168:171]
    v_mfma_f32_16x16x32_bf16 v[172:175], v[100:103], v[204:207], v[172:175]
    s_waitcnt lgkmcnt(0)
    v_mfma_f32_16x16x32_bf16 v[160:163], v[76:79], v[208:211], v[160:163]
    v_mfma_f32_16x16x32_bf16 v[164:167], v[76:79], v[212:215], v[164:167]
    v_mfma_f32_16x16x32_bf16 v[168:171], v[104:107], v[216:219], v[168:171]
    v_mfma_f32_16x16x32_bf16 v[172:175], v[104:107], v[220:223], v[172:175]
    s_lshl_b32 s60, s88, 12
    s_lshl_b32 s61, s89, 3
    s_add_u32 s60, s60, s61
    s_cmp_ge_u32 s89, 14
    s_cselect_b32 s60, 0x40000000, s60
    s_cselect_b32 s61, 0x40000000, 0
    v_lshlrev_b32 v158, 11, v11
    v_lshl_add_u32 v158, v8, 7, v158
    v_and_b32 v4, 1, v9
    v_lshl_add_u32 v158, v4, 2, v158
    s_add_u32 s62, s61, 14336
    v_sub_f32 v140, v160, v168
    v_add_f32 v147, v160, v168
    v_sub_f32 v141, v161, v169
    v_add_f32 v146, v161, v169
    v_sub_f32 v142, v162, v170
    v_add_f32 v145, v162, v170
    v_sub_f32 v143, v163, v171
    v_add_f32 v144, v163, v171
    v_sub_f32 v148, v164, v172
    v_add_f32 v155, v164, v172
    v_sub_f32 v149, v165, v173
    v_add_f32 v154, v165, v173
    v_sub_f32 v150, v166, v174
    v_add_f32 v153, v166, v174
    v_sub_f32 v151, v167, v175
    v_add_f32 v152, v167, v175
    v_cvt_pk_bf16_f32 v20, v140, v141
    v_cvt_pk_bf16_f32 v21, v142, v143
    v_cvt_pk_bf16_f32 v22, v144, v145
    v_cvt_pk_bf16_f32 v23, v146, v147
    v_cvt_pk_bf16_f32 v24, v148, v149
    v_cvt_pk_bf16_f32 v25, v150, v151
    v_cvt_pk_bf16_f32 v26, v152, v153
    v_cvt_pk_bf16_f32 v27, v154, v155
    v_lshlrev_b32 v140, 16, v20
    v_and_b32 v141, 0xffff0000, v20
    v_lshlrev_b32 v142, 16, v21
    v_and_b32 v143, 0xffff0000, v21
    v_lshlrev_b32 v144, 16, v22
    v_and_b32 v145, 0xffff0000, v22
    v_lshlrev_b32 v146, 16, v23
    v_and_b32 v147, 0xffff0000, v23
    v_lshlrev_b32 v148, 16, v24
    v_and_b32 v149, 0xffff0000, v24
    v_lshlrev_b32 v150, 16, v25
    v_and_b32 v151, 0xffff0000, v25
    v_lshlrev_b32 v152, 16, v26
    v_and_b32 v153, 0xffff0000, v26
    v_lshlrev_b32 v154, 16, v27
    v_and_b32 v155, 0xffff0000, v27
    v_pk_add_f32 v[140:141], v[140:141], v[124:125]
    v_pk_add_f32 v[142:143], v[142:143], v[126:127]
    v_pk_add_f32 v[144:145], v[144:145], v[128:129]
    v_pk_add_f32 v[146:147], v[146:147], v[130:131]
    v_pk_add_f32 v[148:149], v[148:149], v[132:133]
    v_pk_add_f32 v[150:151], v[150:151], v[134:135]
    v_pk_add_f32 v[152:153], v[152:153], v[136:137]
    v_pk_add_f32 v[154:155], v[154:155], v[138:139]
    v_cvt_pk_bf16_f32 v20, v140, v141
    v_cvt_pk_bf16_f32 v21, v142, v143
    v_cvt_pk_bf16_f32 v22, v144, v145
    v_cvt_pk_bf16_f32 v23, v146, v147
    v_cvt_pk_bf16_f32 v24, v148, v149
    v_cvt_pk_bf16_f32 v25, v150, v151
    v_cvt_pk_bf16_f32 v26, v152, v153
    v_cvt_pk_bf16_f32 v27, v154, v155
    buffer_store_dwordx2 v[20:21], v116, s[20:23], s61 offen sc0 sc1
    buffer_store_dwordx2 v[22:23], v117, s[20:23], s61 offen sc0 sc1
    buffer_store_dwordx2 v[24:25], v116, s[20:23], s62 offen sc0 sc1
    buffer_store_dwordx2 v[26:27], v117, s[20:23], s62 offen sc0 sc1
    v_lshlrev_b32 v140, 16, v20
    v_and_b32 v141, 0xffff0000, v20
    v_lshlrev_b32 v142, 16, v21
    v_and_b32 v143, 0xffff0000, v21
    v_lshlrev_b32 v144, 16, v22
    v_and_b32 v145, 0xffff0000, v22
    v_lshlrev_b32 v146, 16, v23
    v_and_b32 v147, 0xffff0000, v23
    v_lshlrev_b32 v148, 16, v24
    v_and_b32 v149, 0xffff0000, v24
    v_lshlrev_b32 v150, 16, v25
    v_and_b32 v151, 0xffff0000, v25
    v_lshlrev_b32 v152, 16, v26
    v_and_b32 v153, 0xffff0000, v26
    v_lshlrev_b32 v154, 16, v27
    v_and_b32 v155, 0xffff0000, v27
    v_pk_add_f32 v[160:161], v[140:141], v[142:143]
    v_pk_mul_f32 v[164:165], v[140:141], v[140:141]
    v_pk_add_f32 v[162:163], v[148:149], v[150:151]
    v_pk_mul_f32 v[166:167], v[148:149], v[148:149]
    v_pk_fma_f32 v[164:165], v[142:143], v[142:143], v[164:165]
    v_pk_fma_f32 v[166:167], v[150:151], v[150:151], v[166:167]
    v_pk_add_f32 v[160:161], v[160:161], v[144:145]
    v_pk_fma_f32 v[164:165], v[144:145], v[144:145], v[164:165]
    v_pk_add_f32 v[162:163], v[162:163], v[152:153]
    v_pk_fma_f32 v[166:167], v[152:153], v[152:153], v[166:167]
    v_pk_add_f32 v[160:161], v[160:161], v[146:147]
    v_pk_fma_f32 v[164:165], v[146:147], v[146:147], v[164:165]
    v_pk_add_f32 v[162:163], v[162:163], v[154:155]
    v_pk_fma_f32 v[166:167], v[154:155], v[154:155], v[166:167]
    v_add_f32 v160, v160, v161
    v_add_f32 v164, v164, v165
    v_add_f32 v162, v162, v163
    v_add_f32 v166, v166, v167
    s_nop 0
    v_permlane32_swap_b32 v160, v162
    v_permlane32_swap_b32 v164, v166
    v_add_f32 v160, v160, v162
    v_add_f32 v164, v164, v166
    s_nop 1
    v_permlane16_swap_b32 v160, v164
    v_add_f32 v160, v160, v164
    buffer_store_dword v160, v158, s[96:99], s60 offen sc0 sc1
    s_lshl_b32 s90, s88, 2
    s_lshr_b32 s91, s2, 6
    s_add_u32 s90, s90, s91
    s_lshl_b32 s91, s4, 4
    v_mov_b32 v4, v118
    v_mov_b32 v5, v119
    v_mov_b32 v18, v4
    v_mov_b32 v19, v5
    s_lshl_b32 s60, s90, 7
    s_add_u32 s60, s60, 32768
    v_mov_b32 v4, 1
    v_lshlrev_b32 v5, 20, v0
    v_lshlrev_b32 v233, 7, v0
    v_and_b32 v6, 0xffffe000, v233
    v_lshl_add_u32 v233, v6, 12, v233
    s_waitcnt vmcnt(0)
    s_barrier
    buffer_store_dword v4, v5, s[56:59], s60 offen sc0 sc1
    s_cmp_ge_u32 s2, 224
    s_cbranch_scc1 K_END
    ds_read_b64_tr_b16 a[104:105], v17 offset:0
    ds_read_b64_tr_b16 a[106:107], v17 offset:256
    ds_read_b64_tr_b16 a[108:109], v17 offset:1024
    ds_read_b64_tr_b16 a[110:111], v17 offset:1280
    ds_read_b64_tr_b16 a[112:113], v17 offset:2048
    ds_read_b64_tr_b16 a[114:115], v17 offset:2304
    ds_read_b64_tr_b16 a[116:117], v17 offset:3072
    ds_read_b64_tr_b16 a[118:119], v17 offset:3328
    ds_read_b64_tr_b16 a[120:121], v17 offset:4096
    ds_read_b64_tr_b16 a[122:123], v17 offset:4352
    ds_read_b64_tr_b16 a[124:125], v17 offset:5120
    ds_read_b64_tr_b16 a[126:127], v17 offset:5376
    ds_read_b64_tr_b16 a[128:129], v17 offset:6144
    ds_read_b64_tr_b16 a[130:131], v17 offset:6400
    ds_read_b64_tr_b16 a[132:133], v17 offset:7168
    ds_read_b64_tr_b16 a[134:135], v17 offset:7424
    ds_read_b64_tr_b16 a[136:137], v17 offset:8192
    ds_read_b64_tr_b16 a[138:139], v17 offset:8448
    ds_read_b64_tr_b16 a[140:141], v17 offset:9216
    ds_read_b64_tr_b16 a[142:143], v17 offset:9472
    ds_read_b64_tr_b16 a[144:145], v17 offset:10240
    ds_read_b64_tr_b16 a[146:147], v17 offset:10496
    ds_read_b64_tr_b16 a[148:149], v17 offset:11264
    ds_read_b64_tr_b16 a[150:151], v17 offset:11520
    ds_read_b64_tr_b16 a[152:153], v17 offset:12288
    ds_read_b64_tr_b16 a[154:155], v17 offset:12544
    ds_read_b64_tr_b16 a[156:157], v17 offset:13312
    ds_read_b64_tr_b16 a[158:159], v17 offset:13568
    ds_read_b64_tr_b16 a[160:161], v17 offset:14336
    ds_read_b64_tr_b16 a[162:163], v17 offset:14592
    ds_read_b64_tr_b16 a[164:165], v17 offset:15360
    ds_read_b64_tr_b16 a[166:167], v17 offset:15616
    ds_read_b64_tr_b16 a[168:169], v17 offset:16384
    ds_read_b64_tr_b16 a[170:171], v17 offset:16640
    ds_read_b64_tr_b16 a[172:173], v17 offset:17408
    ds_read_b64_tr_b16 a[174:175], v17 offset:17664
    ds_read_b64_tr_b16 a[176:177], v17 offset:18432
    ds_read_b64_tr_b16 a[178:179], v17 offset:18688
    ds_read_b64_tr_b16 a[180:181], v17 offset:19456
    ds_read_b64_tr_b16 a[182:183], v17 offset:19712
    ds_read_b64_tr_b16 a[184:185], v17 offset:20480
    ds_read_b64_tr_b16 a[186:187], v17 offset:20736
    ds_read_b64_tr_b16 a[188:189], v17 offset:21504
    ds_read_b64_tr_b16 a[190:191], v17 offset:21760
    ds_read_b64_tr_b16 a[192:193], v17 offset:22528
    ds_read_b64_tr_b16 a[194:195], v17 offset:22784
    ds_read_b64_tr_b16 a[196:197], v17 offset:23552
    ds_read_b64_tr_b16 a[198:199], v17 offset:23808
    ds_read_b64_tr_b16 a[200:201], v17 offset:24576
    ds_read_b64_tr_b16 a[202:203], v17 offset:24832
    ds_read_b64_tr_b16 a[204:205], v17 offset:25600
    ds_read_b64_tr_b16 a[206:207], v17 offset:25856
    ds_read_b64_tr_b16 a[208:209], v17 offset:26624
    ds_read_b64_tr_b16 a[210:211], v17 offset:26880
    ds_read_b64_tr_b16 a[212:213], v17 offset:27648
    ds_read_b64_tr_b16 a[214:215], v17 offset:27904
    ds_read_b64_tr_b16 a[216:217], v17 offset:28672
    ds_read_b64_tr_b16 a[218:219], v17 offset:28928
    ds_read_b64_tr_b16 a[220:221], v17 offset:29696
    ds_read_b64_tr_b16 a[222:223], v17 offset:29952
    v_mov_b32 v224, 0x3f803f80
    v_mov_b32 v225, 0x3f803f80
    v_mov_b32 v226, 0x3f803f80
    v_mov_b32 v227, 0x3f803f80
    s_waitcnt lgkmcnt(0)
    s_nop 0
    v_mfma_f32_32x32x16_bf16 v[144:159], v[224:227], a[104:107], 0
    v_mfma_f32_32x32x16_bf16 v[208:223], v[224:227], a[108:111], 0
    v_mfma_f32_32x32x16_bf16 v[144:159], v[224:227], a[112:115], v[144:159]
    v_mfma_f32_32x32x16_bf16 v[208:223], v[224:227], a[116:119], v[208:223]
    v_mfma_f32_32x32x16_bf16 v[144:159], v[224:227], a[120:123], v[144:159]
    v_mfma_f32_32x32x16_bf16 v[208:223], v[224:227], a[124:127], v[208:223]
    v_mfma_f32_32x32x16_bf16 v[144:159], v[224:227], a[128:131], v[144:159]
    v_mfma_f32_32x32x16_bf16 v[208:223], v[224:227], a[132:135], v[208:223]
    v_mfma_f32_32x32x16_bf16 v[144:159], v[224:227], a[136:139], v[144:159]
    v_mfma_f32_32x32x16_bf16 v[208:223], v[224:227], a[140:143], v[208:223]
    v_mfma_f32_32x32x16_bf16 v[144:159], v[224:227], a[144:147], v[144:159]
    v_mfma_f32_32x32x16_bf16 v[208:223], v[224:227], a[148:151], v[208:223]
    v_mfma_f32_32x32x16_bf16 v[144:159], v[224:227], a[152:155], v[144:159]
    v_mfma_f32_32x32x16_bf16 v[208:223], v[224:227], a[156:159], v[208:223]
    v_mfma_f32_32x32x16_bf16 v[144:159], v[224:227], a[160:163], v[144:159]
    s_lshl_b32 s62, s91, 7
    s_add_u32 s62, s62, 32768
    buffer_load_dword v236, v233, s[56:59], s62 offen sc0 sc1
    v_mfma_f32_32x32x16_bf16 v[208:223], v[224:227], a[164:167], v[208:223]
    v_mfma_f32_32x32x16_bf16 v[144:159], v[224:227], a[168:171], v[144:159]
    v_mfma_f32_32x32x16_bf16 v[208:223], v[224:227], a[172:175], v[208:223]
    v_mfma_f32_32x32x16_bf16 v[144:159], v[224:227], a[176:179], v[144:159]
    v_mfma_f32_32x32x16_bf16 v[208:223], v[224:227], a[180:183], v[208:223]
    v_mfma_f32_32x32x16_bf16 v[144:159], v[224:227], a[184:187], v[144:159]
    v_mfma_f32_32x32x16_bf16 v[208:223], v[224:227], a[188:191], v[208:223]
    v_mfma_f32_32x32x16_bf16 v[144:159], v[224:227], a[192:195], v[144:159]
    v_mfma_f32_32x32x16_bf16 v[208:223], v[224:227], a[196:199], v[208:223]
    v_mfma_f32_32x32x16_bf16 v[144:159], v[224:227], a[200:203], v[144:159]
    v_mfma_f32_32x32x16_bf16 v[208:223], v[224:227], a[204:207], v[208:223]
    v_mfma_f32_32x32x16_bf16 v[144:159], v[224:227], a[208:211], v[144:159]
    v_mfma_f32_32x32x16_bf16 v[208:223], v[224:227], a[212:215], v[208:223]
    v_mfma_f32_32x32x16_bf16 v[144:159], v[224:227], a[216:219], v[144:159]
    v_mfma_f32_32x32x16_bf16 v[208:223], v[224:227], a[220:223], v[208:223]
    v_mov_b32 v78, 0
    v_mov_b32 v79, 0
    v_cmp_eq_u32 vcc, 0, v11
    s_nop 1
    v_cndmask_b32 v13, 0, -1, vcc
    v_and_b32 v14, 0xffff, v13
    s_nop 3
    v_add_f32 v18, v18, v144
    v_add_f32 v19, v19, v208
    v_cvt_pk_bf16_f32 v4, v18, v18
    v_lshlrev_b32 v5, 16, v4
    v_sub_f32 v5, v18, v5
    v_cvt_pk_bf16_f32 v68, v18, v5
    v_and_b32 v6, 0xffff0000, v68
    v_sub_f32 v5, v5, v6
    v_cvt_pk_bf16_f32 v69, v5, v5
    v_and_b32 v68, v68, v13
    v_and_b32 v69, v69, v14
    v_mov_b32 v70, 0
    v_mov_b32 v71, 0
    v_cvt_pk_bf16_f32 v4, v19, v19
    v_lshlrev_b32 v5, 16, v4
    v_sub_f32 v5, v19, v5
    v_cvt_pk_bf16_f32 v72, v19, v5
    v_and_b32 v6, 0xffff0000, v72
    v_sub_f32 v5, v5, v6
    v_cvt_pk_bf16_f32 v73, v5, v5
    v_and_b32 v72, v72, v13
    v_and_b32 v73, v73, v14
    v_mov_b32 v74, 0
    v_mov_b32 v75, 0
    v_lshrrev_b32 v4, 3, v1
    v_lshrrev_b32 v5, 1, v4
    v_xor_b32 v5, v5, v1
    s_and_b32 s61, s3, 1
    s_lshl_b32 s61, s61, 2
    v_xor_b32 v5, s61, v5
    v_and_b32 v5, 7, v5
    s_lshl_b32 s60, s4, 7
    s_lshl_b32 s61, s3, 3
    s_add_u32 s61, s60, s61
    v_add_u32 v4, s61, v4
    v_mul_u32_u24 v4, 896, v4
    v_lshl_add_u32 v20, v5, 4, v4
    s_lshl_b32 s61, s3, 5
    s_add_u32 s60, s60, s61
    v_add_u32 v4, s60, v10
    v_lshlrev_b32 v4, 7, v4
    v_lshl_add_u32 v2, v11, 6, v4
    v_lshl_add_u32 v3, v11, 30, v2
    s_lshl_b32 s61, s5, 2
    s_add_u32 s61, s61, s3
    s_mul_i32 s62, s4, 458752
    s_lshl_b32 s63, s61, 11
    s_add_u32 s62, s62, s63
    v_add_u32 v15, s62, v12
    v_lshrrev_b32 v4, 3, v10
    v_lshlrev_b32 v4, 10, v4
    v_and_b32 v5, 7, v10
    v_lshl_add_u32 v4, v5, 7, v4
    v_bfe_u32 v5, v10, 1, 3
    v_xor_b32 v5, v5, v11
    v_xor_b32 v6, 0, v5
    v_lshl_add_u32 v21, v6, 4, v4
    v_xor_b32 v6, 2, v5
    v_lshl_add_u32 v22, v6, 4, v4
    v_xor_b32 v6, 4, v5
    v_lshl_add_u32 v23, v6, 4, v4
    v_xor_b32 v6, 6, v5
    v_lshl_add_u32 v24, v6, 4, v4
    s_mov_b32 s62, 0x1c000
    v_lshl_add_u32 v26, v10, 4, s62
    s_lshl_b32 s62, s3, 9
    v_add_u32 v25, s62, v26
    s_lshr_b32 s62, s2, 5
    s_mul_i32 s62, s62, 229376
    s_mul_i32 s63, s3, 28672
    s_add_u32 s62, s62, s63
    v_add_u32 v27, s62, v12
    s_lshl_b32 s54, s4, 4
    s_add_u32 s54, s54, s5
    s_lshl_b32 s54, s54, 7
    s_and_b32 s62, s2, 7
    s_lshr_b32 s63, s2, 3
    s_and_b32 s63, s63, 3
    s_lshl_b32 s52, s62, 2
    s_add_u32 s52, s52, s63
    s_lshr_b32 s53, s2, 5
    s_lshr_b32 s55, s52, 1
    s_lshl_b32 s55, s55, 11
    v_lshlrev_b32 v28, 20, v0
    v_lshlrev_b32 v29, 7, v0
    v_and_b32 v4, 0xffffe000, v29
    v_lshl_add_u32 v29, v4, 12, v29
    s_mov_b32 s61, 128
    s_mov_b32 s60, 0
    s_waitcnt vmcnt(0)
    s_cmp_lg_u32 s3, 0
    s_cbranch_scc1 SY3_JOIN
SY3_POLL:
    v_cmp_eq_u32 vcc, 0, v236
    s_nop 1
    s_and_b64 vcc, vcc, 0xffff
    s_cmp_eq_u64 vcc, 0
    s_cbranch_scc1 SY3_JOIN
    s_add_u32 s60, s60, 1
    s_cmp_ge_u32 s60, 0x40000
    s_cbranch_scc1 SY3_JOIN
    s_lshl_b32 s62, s91, 7
    s_add_u32 s62, s62, 32768
    buffer_load_dword v236, v233, s[56:59], s62 offen sc0 sc1
    s_waitcnt vmcnt(0)
    s_branch SY3_POLL
    s_nop 7
    s_nop 3
SY3_JOIN:
    s_barrier
    s_lshl_b32 s90, s3, 10
    s_mul_i32 s91, s3, 10240
    s_add_u32 s91, s91, 116736
    s_add_u32 m0, s90, 0
    s_mov_b32 s63, 0
    buffer_load_dwordx4 v20, s[20:23], s63 offen sc0 sc1 lds
    s_add_u32 m0, s90, 16384
    s_mov_b32 s63, 128
    buffer_load_dwordx4 v20, s[20:23], s63 offen sc0 sc1 lds
    s_add_u32 m0, s90, 32768
    s_mov_b32 s63, 256
    buffer_load_dwordx4 v20, s[20:23], s63 offen sc0 sc1 lds
    buffer_load_dwordx4 v[80:83], v2, s[96:99], 0 offen offset:0 sc0 sc1
    buffer_load_dwordx4 v[84:87], v2, s[96:99], 0 offen offset:16 sc0 sc1
    buffer_load_dwordx4 v[88:91], v2, s[96:99], 0 offen offset:32 sc0 sc1
    buffer_load_dwordx4 v[92:95], v3, s[96:99], 0 offen offset:48 sc0 sc1
    s_add_u32 m0, s90, 4096
    s_mov_b32 s63, 28672
    buffer_load_dwordx4 v20, s[20:23], s63 offen sc0 sc1 lds
    s_add_u32 m0, s90, 20480
    s_mov_b32 s63, 28800
    buffer_load_dwordx4 v20, s[20:23], s63 offen sc0 sc1 lds
    s_add_u32 m0, s90, 36864
    s_mov_b32 s63, 28928
    buffer_load_dwordx4 v20, s[20:23], s63 offen sc0 sc1 lds
    s_waitcnt vmcnt(8)
    s_barrier
    ds_read_b128 v[232:235], v21 offset:0
    ds_read_b128 v[236:239], v22 offset:0
    ds_read_b128 v[240:243], v23 offset:0
    ds_read_b128 v[244:247], v24 offset:0
    s_waitcnt lgkmcnt(3)
    v_mfma_f32_32x32x16_bf16 v[96:111], a[0:3], v[232:235], 0
    s_add_u32 m0, s90, 8192
    s_mov_b32 s63, 57344
    buffer_load_dwordx4 v20, s[20:23], s63 offen sc0 sc1 lds
    v_mfma_f32_32x32x16_bf16 v[160:175], a[4:7], v[232:235], 0
    ds_read_b128 v[232:235], v21 offset:16384
    s_waitcnt lgkmcnt(3)
    v_mfma_f32_32x32x16_bf16 v[96:111], a[8:11], v[236:239], v[96:111]
    s_add_u32 m0, s90, 24576
    s_mov_b32 s63, 57472
    buffer_load_dwordx4 v20, s[20:23], s63 offen sc0 sc1 lds
    s_waitcnt vmcnt(5)
    v_pk_add_f32 v[80:81], v[80:81], v[84:85]
    v_pk_add_f32 v[82:83], v[82:83], v[86:87]
    v_pk_add_f32 v[80:81], v[80:81], v[88:89]
    v_mfma_f32_32x32x16_bf16 v[160:175], a[12:15], v[236:239], v[160:175]
    v_pk_add_f32 v[82:83], v[82:83], v[90:91]
    v_pk_add_f32 v[80:81], v[80:81], v[92:93]
    v_pk_add_f32 v[82:83], v[82:83], v[94:95]
    v_pk_add_f32 v[80:81], v[80:81], v[82:83]
    v_mov_b32 v82, v80
    ds_read_b128 v[236:239], v22 offset:16384
    s_waitcnt lgkmcnt(3)
    v_mfma_f32_32x32x16_bf16 v[96:111], a[16:19], v[240:243], v[96:111]
    s_add_u32 m0, s90, 40960
    s_mov_b32 s63, 57600
    buffer_load_dwordx4 v20, s[20:23], s63 offen sc0 sc1 lds
    v_mov_b32 v83, v81
    v_permlane32_swap_b32 v80, v82
    s_nop 0
    v_permlane32_swap_b32 v81, v83
    v_pk_add_f32 v[80:81], v[80:81], v[82:83]
    v_mfma_f32_32x32x16_bf16 v[160:175], a[20:23], v[240:243], v[160:175]
    v_mul_f32 v80, 0x3b124925, v80
    v_mul_f32 v82, 0x3b124925, v81
    v_fma_f32 v82, -v80, v80, v82
    v_max_f32 v82, 0, v82
    v_cvt_pk_bf16_f32 v80, -v80, -v80
    ds_read_b128 v[240:243], v23 offset:16384
    s_waitcnt lgkmcnt(3)
    v_mfma_f32_32x32x16_bf16 v[96:111], a[24:27], v[244:247], v[96:111]
    s_add_u32 m0, s90, 12288
    s_mov_b32 s63, 86016
    buffer_load_dwordx4 v20, s[20:23], s63 offen sc0 sc1 lds
    v_cvt_pk_bf16_f32 v82, v82, v82
    v_lshlrev_b32 v82, 16, v82
    v_add_f32 v82, 0x3727c5ac, v82
    v_cvt_pk_bf16_f32 v82, v82, v82
    v_mfma_f32_32x32x16_bf16 v[160:175], a[28:31], v[244:247], v[160:175]
    v_lshlrev_b32 v82, 16, v82
    v_sqrt_f32 v82, v82
    s_nop 0
    v_cvt_pk_bf16_f32 v82, v82, v82
    v_lshlrev_b32 v82, 16, v82
    ds_read_b128 v[244:247], v24 offset:16384
    s_waitcnt lgkmcnt(3)
    v_mfma_f32_32x32x16_bf16 v[96:111], a[32:35], v[232:235], v[96:111]
    s_add_u32 m0, s90, 28672
    s_mov_b32 s63, 86144
    buffer_load_dwordx4 v20, s[20:23], s63 offen sc0 sc1 lds
    v_rcp_f32 v81, v82
    s_nop 0
    v_mul_f32 v81, 0xbfb8aa3b, v81
    ds_write_b128 v25, v[80:83]
    v_mfma_f32_32x32x16_bf16 v[160:175], a[36:39], v[232:235], v[160:175]
    s_waitcnt vmcnt(12)
    s_barrier
    ds_read_b128 v[232:235], v21 offset:32768
    s_waitcnt lgkmcnt(4)
    v_mfma_f32_32x32x16_bf16 v[96:111], a[40:43], v[236:239], v[96:111]
    s_add_u32 m0, s90, 45056
    s_mov_b32 s63, 86272
    buffer_load_dwordx4 v20, s[20:23], s63 offen sc0 sc1 lds
    v_mfma_f32_32x32x16_bf16 v[160:175], a[44:47], v[236:239], v[160:175]
    ds_read_b128 v[236:239], v22 offset:32768
    s_waitcnt lgkmcnt(4)
    v_mfma_f32_32x32x16_bf16 v[96:111], a[48:51], v[240:243], v[96:111]
    s_add_u32 m0, s90, 49152
    s_mov_b32 s63, 384
    buffer_load_dwordx4 v20, s[20:23], s63 offen sc0 sc1 lds
    v_mfma_f32_32x32x16_bf16 v[160:175], a[52:55], v[240:243], v[160:175]
    ds_read_b128 v[240:243], v23 offset:32768
    s_waitcnt lgkmcnt(4)
    v_mfma_f32_32x32x16_bf16 v[96:111], a[56:59], v[244:247], v[96:111]
    s_add_u32 m0, s90, 65536
    s_mov_b32 s63, 512
    buffer_load_dwordx4 v20, s[20:23], s63 offen sc0 sc1 lds
    v_mfma_f32_32x32x16_bf16 v[160:175], a[60:63], v[244:247], v[160:175]
    ds_read_b128 v[244:247], v24 offset:32768
    s_waitcnt lgkmcnt(3)
    v_mfma_f32_32x32x16_bf16 v[96:111], a[64:67], v[232:235], v[96:111]
    s_add_u32 m0, s90, 81920
    s_mov_b32 s63, 640
    buffer_load_dwordx4 v20, s[20:23], s63 offen sc0 sc1 lds
    v_mfma_f32_32x32x16_bf16 v[160:175], a[68:71], v[232:235], v[160:175]
    v_add_u32 v30, 0x10000, v21
    v_add_u32 v31, 0x10000, v22
    v_add_u32 v16, 0x10000, v23
    v_add_u32 v18, 0x10000, v24
    s_waitcnt vmcnt(9)
    s_barrier
    ds_read_b128 v[232:235], v21 offset:4096
    s_waitcnt lgkmcnt(3)
    v_mfma_f32_32x32x16_bf16 v[96:111], a[72:75], v[236:239], v[96:111]
    s_add_u32 m0, s90, 98304
    s_mov_b32 s63, 768
    buffer_load_dwordx4 v20, s[20:23], s63 offen sc0 sc1 lds
    v_mfma_f32_32x32x16_bf16 v[160:175], a[76:79], v[236:239], v[160:175]
    ds_read_b128 v[236:239], v22 offset:4096
    s_waitcnt lgkmcnt(3)
    v_mfma_f32_32x32x16_bf16 v[96:111], a[80:83], v[240:243], v[96:111]
    s_add_u32 m0, s90, 53248
    s_mov_b32 s63, 29056
    buffer_load_dwordx4 v20, s[20:23], s63 offen sc0 sc1 lds
    v_mfma_f32_32x32x16_bf16 v[160:175], a[84:87], v[240:243], v[160:175]
    ds_read_b128 v[240:243], v23 offset:4096
    s_waitcnt lgkmcnt(3)
    v_mfma_f32_32x32x16_bf16 v[96:111], a[88:91], v[244:247], v[96:111]
    s_add_u32 m0, s90, 69632
    s_mov_b32 s63, 29184
    buffer_load_dwordx4 v20, s[20:23], s63 offen sc0 sc1 lds
    v_mfma_f32_32x32x16_bf16 v[160:175], a[92:95], v[244:247], v[160:175]
    ds_read_b128 v[244:247], v24 offset:4096
    s_waitcnt lgkmcnt(3)
    v_mfma_f32_32x32x16_bf16 v[112:127], a[0:3], v[232:235], 0
    s_add_u32 m0, s90, 86016
    s_mov_b32 s63, 29312
    buffer_load_dwordx4 v20, s[20:23], s63 offen sc0 sc1 lds
    v_mfma_f32_32x32x16_bf16 v[176:191], a[4:7], v[232:235], 0
    ds_read_b128 v[232:235], v21 offset:20480
    s_waitcnt lgkmcnt(3)
    v_mfma_f32_32x32x16_bf16 v[112:127], a[8:11], v[236:239], v[112:127]
    s_add_u32 m0, s90, 102400
    s_mov_b32 s63, 29440
    buffer_load_dwordx4 v20, s[20:23], s63 offen sc0 sc1 lds
    v_mfma_f32_32x32x16_bf16 v[176:191], a[12:15], v[236:239], v[176:191]
    ds_read_b128 v[236:239], v22 offset:20480
    s_waitcnt lgkmcnt(3)
    v_mfma_f32_32x32x16_bf16 v[112:127], a[16:19], v[240:243], v[112:127]
    s_add_u32 m0, s90, 57344
    s_mov_b32 s63, 57728
    buffer_load_dwordx4 v20, s[20:23], s63 offen sc0 sc1 lds
    v_mfma_f32_32x32x16_bf16 v[176:191], a[20:23], v[240:243], v[176:191]
    ds_read_b128 v[240:243], v23 offset:20480
    s_waitcnt lgkmcnt(3)
    v_mfma_f32_32x32x16_bf16 v[112:127], a[24:27], v[244:247], v[112:127]
    s_add_u32 m0, s90, 73728
    s_mov_b32 s63, 57856
    buffer_load_dwordx4 v20, s[20:23], s63 offen sc0 sc1 lds
    v_mfma_f32_32x32x16_bf16 v[176:191], a[28:31], v[244:247], v[176:191]
    ds_read_b128 v[244:247], v24 offset:20480
    s_waitcnt lgkmcnt(3)
    v_mfma_f32_32x32x16_bf16 v[112:127], a[32:35], v[232:235], v[112:127]
    s_add_u32 m0, s90, 90112
    s_mov_b32 s63, 57984
    buffer_load_dwordx4 v20, s[20:23], s63 offen sc0 sc1 lds
    v_mfma_f32_32x32x16_bf16 v[176:191], a[36:39], v[232:235], v[176:191]
    ds_read_b128 v[232:235], v21 offset:36864
    s_waitcnt lgkmcnt(3)
    v_mfma_f32_32x32x16_bf16 v[112:127], a[40:43], v[236:239], v[112:127]
    s_add_u32 m0, s90, 106496
    s_mov_b32 s63, 58112
    buffer_load_dwordx4 v20, s[20:23], s63 offen sc0 sc1 lds
    v_mfma_f32_32x32x16_bf16 v[176:191], a[44:47], v[236:239], v[176:191]
    ds_read_b128 v[236:239], v22 offset:36864
    s_waitcnt lgkmcnt(3)
    v_mfma_f32_32x32x16_bf16 v[112:127], a[48:51], v[240:243], v[112:127]
    s_add_u32 m0, s90, 61440
    s_mov_b32 s63, 86400
    buffer_load_dwordx4 v20, s[20:23], s63 offen sc0 sc1 lds
    v_mfma_f32_32x32x16_bf16 v[176:191], a[52:55], v[240:243], v[176:191]
    ds_read_b128 v[240:243], v23 offset:36864
    s_waitcnt lgkmcnt(3)
    v_mfma_f32_32x32x16_bf16 v[112:127], a[56:59], v[244:247], v[112:127]
    s_add_u32 m0, s90, 77824
    s_mov_b32 s63, 86528
    buffer_load_dwordx4 v20, s[20:23], s63 offen sc0 sc1 lds
    v_mfma_f32_32x32x16_bf16 v[176:191], a[60:63], v[244:247], v[176:191]
    ds_read_b128 v[244:247], v24 offset:36864
    s_waitcnt lgkmcnt(3)
    v_mfma_f32_32x32x16_bf16 v[112:127], a[64:67], v[232:235], v[112:127]
    s_add_u32 m0, s90, 94208
    s_mov_b32 s63, 86656
    buffer_load_dwordx4 v20, s[20:23], s63 offen sc0 sc1 lds
    v_mfma_f32_32x32x16_bf16 v[176:191], a[68:71], v[232:235], v[176:191]
    s_waitcnt vmcnt(18)
    s_barrier
    ds_read_b128 v[232:235], v21 offset:8192
    s_waitcnt lgkmcnt(3)
    v_mfma_f32_32x32x16_bf16 v[112:127], a[72:75], v[236:239], v[112:127]
    s_add_u32 m0, s90, 110592
    s_mov_b32 s63, 86784
    buffer_load_dwordx4 v20, s[20:23], s63 offen sc0 sc1 lds
    v_mfma_f32_32x32x16_bf16 v[176:191], a[76:79], v[236:239], v[176:191]
    ds_read_b128 v[236:239], v22 offset:8192
    s_waitcnt lgkmcnt(3)
    v_mfma_f32_32x32x16_bf16 v[112:127], a[80:83], v[240:243], v[112:127]
    s_mov_b32 s62, 14336
    buffer_load_dwordx4 a[224:227], v27, s[44:47], s62 offen
    v_mfma_f32_32x32x16_bf16 v[176:191], a[84:87], v[240:243], v[176:191]
    ds_read_b128 v[240:243], v23 offset:8192
    s_waitcnt lgkmcnt(3)
    v_mfma_f32_32x32x16_bf16 v[112:127], a[88:91], v[244:247], v[112:127]
    s_mov_b32 s62, 129024
    buffer_load_dwordx4 a[228:231], v27, s[44:47], s62 offen
    v_mfma_f32_32x32x16_bf16 v[176:191], a[92:95], v[244:247], v[176:191]
    ds_read_b128 v[244:247], v24 offset:8192
    s_waitcnt lgkmcnt(3)
    v_mfma_f32_32x32x16_bf16 v[128:143], a[0:3], v[232:235], 0
    s_mov_b32 s62, 15360
    buffer_load_dwordx4 a[232:235], v27, s[44:47], s62 offen
    v_mfma_f32_32x32x16_bf16 v[192:207], a[4:7], v[232:235], 0
    ds_read_b128 v[232:235], v21 offset:24576
    s_waitcnt lgkmcnt(3)
    v_mfma_f32_32x32x16_bf16 v[128:143], a[8:11], v[236:239], v[128:143]
    s_mov_b32 s62, 130048
    buffer_load_dwordx4 a[236:239], v27, s[44:47], s62 offen
    v_mfma_f32_32x32x16_bf16 v[192:207], a[12:15], v[236:239], v[192:207]
    ds_read_b128 v[236:239], v22 offset:24576
    s_waitcnt lgkmcnt(3)
    v_mfma_f32_32x32x16_bf16 v[128:143], a[16:19], v[240:243], v[128:143]
    s_mov_b32 s62, 16384
    buffer_load_dwordx4 a[240:243], v27, s[44:47], s62 offen
    v_mfma_f32_32x32x16_bf16 v[192:207], a[20:23], v[240:243], v[192:207]
    ds_read_b128 v[240:243], v23 offset:24576
    s_waitcnt lgkmcnt(3)
    v_mfma_f32_32x32x16_bf16 v[128:143], a[24:27], v[244:247], v[128:143]
    s_mov_b32 s62, 131072
    buffer_load_dwordx4 a[244:247], v27, s[44:47], s62 offen
    v_mfma_f32_32x32x16_bf16 v[192:207], a[28:31], v[244:247], v[192:207]
    ds_read_b128 v[244:247], v24 offset:24576
    s_waitcnt lgkmcnt(3)
    v_mfma_f32_32x32x16_bf16 v[128:143], a[32:35], v[232:235], v[128:143]
    s_mov_b32 s62, 17408
    buffer_load_dwordx4 a[248:251], v27, s[44:47], s62 offen
    v_mfma_f32_32x32x16_bf16 v[192:207], a[36:39], v[232:235], v[192:207]
    ds_read_b128 v[232:235], v21 offset:40960
    s_waitcnt lgkmcnt(3)
    v_mfma_f32_32x32x16_bf16 v[128:143], a[40:43], v[236:239], v[128:143]
    s_mov_b32 s62, 132096
    buffer_load_dwordx4 a[252:255], v27, s[44:47], s62 offen
    v_mfma_f32_32x32x16_bf16 v[192:207], a[44:47], v[236:239], v[192:207]
    ds_read_b128 v[236:239], v22 offset:40960
    s_waitcnt lgkmcnt(3)
    v_mfma_f32_32x32x16_bf16 v[128:143], a[48:51], v[240:243], v[128:143]
    s_mov_b32 s62, 18432
    buffer_load_dwordx4 v[36:39], v27, s[44:47], s62 offen
    v_mfma_f32_32x32x16_bf16 v[192:207], a[52:55], v[240:243], v[192:207]
    ds_read_b128 v[240:243], v23 offset:40960
    s_waitcnt lgkmcnt(3)
    v_mfma_f32_32x32x16_bf16 v[128:143], a[56:59], v[244:247], v[128:143]
    s_mov_b32 s62, 133120
    buffer_load_dwordx4 v[40:43], v27, s[44:47], s62 offen
    v_mfma_f32_32x32x16_bf16 v[192:207], a[60:63], v[244:247], v[192:207]
    ds_read_b128 v[244:247], v24 offset:40960
    s_waitcnt lgkmcnt(3)
    v_mfma_f32_32x32x16_bf16 v[128:143], a[64:67], v[232:235], v[128:143]
    s_mov_b32 s62, 19456
    buffer_load_dwordx4 v[44:47], v27, s[44:47], s62 offen
    v_mfma_f32_32x32x16_bf16 v[192:207], a[68:71], v[232:235], v[192:207]
    s_waitcnt vmcnt(27)
    s_barrier
    ds_read_b128 v[232:235], v21 offset:12288
    s_waitcnt lgkmcnt(3)
    v_mfma_f32_32x32x16_bf16 v[128:143], a[72:75], v[236:239], v[128:143]
    s_mov_b32 s62, 134144
    buffer_load_dwordx4 v[48:51], v27, s[44:47], s62 offen
    v_mfma_f32_32x32x16_bf16 v[192:207], a[76:79], v[236:239], v[192:207]
    ds_read_b128 v[236:239], v22 offset:12288
    s_waitcnt lgkmcnt(3)
    v_mfma_f32_32x32x16_bf16 v[128:143], a[80:83], v[240:243], v[128:143]
    s_mov_b32 s62, 20480
    buffer_load_dwordx4 v[52:55], v27, s[44:47], s62 offen
    v_mfma_f32_32x32x16_bf16 v[192:207], a[84:87], v[240:243], v[192:207]
    ds_read_b128 v[240:243], v23 offset:12288
    s_waitcnt lgkmcnt(3)
    v_mfma_f32_32x32x16_bf16 v[128:143], a[88:91], v[244:247], v[128:143]
    s_mov_b32 s62, 135168
    buffer_load_dwordx4 v[56:59], v27, s[44:47], s62 offen
    v_mfma_f32_32x32x16_bf16 v[192:207], a[92:95], v[244:247], v[192:207]
    ds_read_b128 v[244:247], v24 offset:12288
    s_waitcnt lgkmcnt(3)
    v_mfma_f32_32x32x16_bf16 v[144:159], a[0:3], v[232:235], 0
    s_mov_b32 s62, 21504
    buffer_load_dwordx4 v[60:63], v27, s[44:47], s62 offen
    v_mfma_f32_32x32x16_bf16 v[208:223], a[4:7], v[232:235], 0
    ds_read_b128 v[232:235], v21 offset:28672
    s_waitcnt lgkmcnt(3)
    v_mfma_f32_32x32x16_bf16 v[144:159], a[8:11], v[236:239], v[144:159]
    s_mov_b32 s62, 136192
    buffer_load_dwordx4 v[64:67], v27, s[44:47], s62 offen
    v_mfma_f32_32x32x16_bf16 v[208:223], a[12:15], v[236:239], v[208:223]
    ds_read_b128 v[236:239], v22 offset:28672
    s_waitcnt lgkmcnt(3)
    v_mfma_f32_32x32x16_bf16 v[144:159], a[16:19], v[240:243], v[144:159]
    s_add_u32 m0, s91, 0
    s_mov_b32 s62, 22528
    buffer_load_dwordx4 v27, s[44:47], s62 offen lds
    v_mfma_f32_32x32x16_bf16 v[208:223], a[20:23], v[240:243], v[208:223]
    ds_read_b128 v[240:243], v23 offset:28672
    s_waitcnt lgkmcnt(3)
    v_mfma_f32_32x32x16_bf16 v[144:159], a[24:27], v[244:247], v[144:159]
    s_add_u32 m0, s91, 1024
    s_mov_b32 s62, 137216
    buffer_load_dwordx4 v27, s[44:47], s62 offen lds
    v_mfma_f32_32x32x16_bf16 v[208:223], a[28:31], v[244:247], v[208:223]
    ds_read_b128 v[244:247], v24 offset:28672
    s_waitcnt lgkmcnt(3)
    v_mfma_f32_32x32x16_bf16 v[144:159], a[32:35], v[232:235], v[144:159]
    s_add_u32 m0, s91, 2048
    s_mov_b32 s62, 23552
    buffer_load_dwordx4 v27, s[44:47], s62 offen lds
    v_mfma_f32_32x32x16_bf16 v[208:223], a[36:39], v[232:235], v[208:223]
    ds_read_b128 v[232:235], v21 offset:45056
    s_waitcnt lgkmcnt(3)
    v_mfma_f32_32x32x16_bf16 v[144:159], a[40:43], v[236:239], v[144:159]
    s_add_u32 m0, s91, 3072
    s_mov_b32 s62, 138240
    buffer_load_dwordx4 v27, s[44:47], s62 offen lds
    v_mfma_f32_32x32x16_bf16 v[208:223], a[44:47], v[236:239], v[208:223]
    ds_read_b128 v[236:239], v22 offset:45056
    s_waitcnt lgkmcnt(3)
    v_mfma_f32_32x32x16_bf16 v[144:159], a[48:51], v[240:243], v[144:159]
    s_add_u32 m0, s91, 4096
    s_mov_b32 s62, 24576
    buffer_load_dwordx4 v27, s[44:47], s62 offen lds
    v_mfma_f32_32x32x16_bf16 v[208:223], a[52:55], v[240:243], v[208:223]
    ds_read_b128 v[240:243], v23 offset:45056
    s_waitcnt lgkmcnt(3)
    v_mfma_f32_32x32x16_bf16 v[144:159], a[56:59], v[244:247], v[144:159]
    s_add_u32 m0, s91, 5120
    s_mov_b32 s62, 139264
    buffer_load_dwordx4 v27, s[44:47], s62 offen lds
    v_mfma_f32_32x32x16_bf16 v[208:223], a[60:63], v[244:247], v[208:223]
    ds_read_b128 v[244:247], v24 offset:45056
    s_waitcnt lgkmcnt(3)
    v_mfma_f32_32x32x16_bf16 v[144:159], a[64:67], v[232:235], v[144:159]
    s_add_u32 m0, s91, 6144
    s_mov_b32 s62, 25600
    buffer_load_dwordx4 v27, s[44:47], s62 offen lds
    v_mfma_f32_32x32x16_bf16 v[208:223], a[68:71], v[232:235], v[208:223]
    s_waitcnt vmcnt(23)
    s_waitcnt lgkmcnt(0)
    s_barrier
    ds_read_b128 v[80:83], v26 offset:0
    ds_read_b128 v[84:87], v26 offset:512
    ds_read_b128 v[88:91], v26 offset:1024
    ds_read_b128 v[92:95], v26 offset:1536
    ds_read_b128 v[232:235], v21 offset:49152
    s_waitcnt lgkmcnt(7)
    v_mfma_f32_32x32x16_bf16 v[144:159], a[72:75], v[236:239], v[144:159]
    s_add_u32 m0, s91, 7168
    s_mov_b32 s62, 140288
    buffer_load_dwordx4 v27, s[44:47], s62 offen lds
    v_mfma_f32_32x32x16_bf16 v[208:223], a[76:79], v[236:239], v[208:223]
    ds_read_b128 v[236:239], v22 offset:49152
    s_waitcnt lgkmcnt(7)
    v_mfma_f32_32x32x16_bf16 v[144:159], a[80:83], v[240:243], v[144:159]
    s_add_u32 m0, s91, 8192
    s_mov_b32 s62, 26624
    buffer_load_dwordx4 v27, s[44:47], s62 offen lds
    v_mfma_f32_32x32x16_bf16 v[208:223], a[84:87], v[240:243], v[208:223]
    ds_read_b128 v[240:243], v23 offset:49152
    s_waitcnt lgkmcnt(7)
    v_mfma_f32_32x32x16_bf16 v[144:159], a[88:91], v[244:247], v[144:159]
    s_add_u32 m0, s91, 9216
    s_mov_b32 s62, 141312
    buffer_load_dwordx4 v27, s[44:47], s62 offen lds
    v_mfma_f32_32x32x16_bf16 v[208:223], a[92:95], v[244:247], v[208:223]
    ds_read_b128 v[244:247], v24 offset:49152
    s_waitcnt lgkmcnt(3)
    v_mfma_f32_32x32x16_bf16 v[96:111], a[96:99], v[232:235], v[96:111]
    s_mov_b32 s62, 0
    buffer_load_dwordx4 a[0:3], v27, s[44:47], s62 offen
    v_mfma_f32_32x32x16_bf16 v[160:175], a[100:103], v[232:235], v[160:175]
    ds_read_b128 v[232:235], v30 offset:0
    s_waitcnt lgkmcnt(3)
    v_mfma_f32_32x32x16_bf16 v[96:111], a[104:107], v[236:239], v[96:111]
    s_mov_b32 s62, 114688
    buffer_load_dwordx4 a[4:7], v27, s[44:47], s62 offen
    v_mfma_f32_32x32x16_bf16 v[160:175], a[108:111], v[236:239], v[160:175]
    ds_read_b128 v[236:239], v31 offset:0
    s_waitcnt lgkmcnt(3)
    v_mfma_f32_32x32x16_bf16 v[96:111], a[112:115], v[240:243], v[96:111]
    s_mov_b32 s62, 1024
    buffer_load_dwordx4 a[8:11], v27, s[44:47], s62 offen
    v_mfma_f32_32x32x16_bf16 v[160:175], a[116:119], v[240:243], v[160:175]
    ds_read_b128 v[240:243], v16 offset:0
    s_waitcnt lgkmcnt(3)
    v_mfma_f32_32x32x16_bf16 v[96:111], a[120:123], v[244:247], v[96:111]
    s_mov_b32 s62, 115712
    buffer_load_dwordx4 a[12:15], v27, s[44:47], s62 offen
    v_mfma_f32_32x32x16_bf16 v[160:175], a[124:127], v[244:247], v[160:175]
    ds_read_b128 v[244:247], v18 offset:0
    s_waitcnt lgkmcnt(3)
    v_mfma_f32_32x32x16_bf16 v[96:111], a[128:131], v[232:235], v[96:111]
    s_mov_b32 s62, 2048
    buffer_load_dwordx4 a[16:19], v27, s[44:47], s62 offen
    v_mfma_f32_32x32x16_bf16 v[160:175], a[132:135], v[232:235], v[160:175]
    ds_read_b128 v[232:235], v30 offset:16384
    s_waitcnt lgkmcnt(3)
    v_mfma_f32_32x32x16_bf16 v[96:111], a[136:139], v[236:239], v[96:111]
    s_mov_b32 s62, 116736
    buffer_load_dwordx4 a[20:23], v27, s[44:47], s62 offen
    v_mfma_f32_32x32x16_bf16 v[160:175], a[140:143], v[236:239], v[160:175]
    ds_read_b128 v[236:239], v31 offset:16384
    s_waitcnt lgkmcnt(3)
    v_mfma_f32_32x32x16_bf16 v[96:111], a[144:147], v[240:243], v[96:111]
    s_mov_b32 s62, 3072
    buffer_load_dwordx4 a[24:27], v27, s[44:47], s62 offen
    v_mfma_f32_32x32x16_bf16 v[160:175], a[148:151], v[240:243], v[160:175]
    ds_read_b128 v[240:243], v16 offset:16384
    s_waitcnt lgkmcnt(3)
    v_mfma_f32_32x32x16_bf16 v[96:111], a[152:155], v[244:247], v[96:111]
    s_mov_b32 s62, 117760
    buffer_load_dwordx4 a[28:31], v27, s[44:47], s62 offen
    v_mfma_f32_32x32x16_bf16 v[160:175], a[156:159], v[244:247], v[160:175]
    ds_read_b128 v[244:247], v18 offset:16384
    s_waitcnt lgkmcnt(3)
    v_mfma_f32_32x32x16_bf16 v[96:111], a[160:163], v[232:235], v[96:111]
    s_mov_b32 s62, 4096
    buffer_load_dwordx4 a[32:35], v27, s[44:47], s62 offen
    v_mfma_f32_32x32x16_bf16 v[160:175], a[164:167], v[232:235], v[160:175]
    ds_read_b128 v[232:235], v30 offset:32768
    s_waitcnt lgkmcnt(3)
    v_mfma_f32_32x32x16_bf16 v[96:111], a[168:171], v[236:239], v[96:111]
    s_mov_b32 s62, 118784
    buffer_load_dwordx4 a[36:39], v27, s[44:47], s62 offen
    v_mfma_f32_32x32x16_bf16 v[160:175], a[172:175], v[236:239], v[160:175]
    ds_read_b128 v[236:239], v31 offset:32768
    s_waitcnt lgkmcnt(3)
    v_mfma_f32_32x32x16_bf16 v[96:111], a[176:179], v[240:243], v[96:111]
    s_mov_b32 s62, 5120
    buffer_load_dwordx4 a[40:43], v27, s[44:47], s62 offen
    v_mfma_f32_32x32x16_bf16 v[160:175], a[180:183], v[240:243], v[160:175]
    ds_read_b128 v[240:243], v16 offset:32768
    s_waitcnt lgkmcnt(3)
    v_mfma_f32_32x32x16_bf16 v[96:111], a[184:187], v[244:247], v[96:111]
    s_mov_b32 s62, 119808
    buffer_load_dwordx4 a[44:47], v27, s[44:47], s62 offen
    v_mfma_f32_32x32x16_bf16 v[160:175], a[188:191], v[244:247], v[160:175]
    ds_read_b128 v[244:247], v18 offset:32768
    s_waitcnt lgkmcnt(3)
    v_mfma_f32_32x32x16_bf16 v[96:111], a[192:195], v[232:235], v[96:111]
    s_mov_b32 s62, 6144
    buffer_load_dwordx4 a[48:51], v27, s[44:47], s62 offen
    v_mfma_f32_32x32x16_bf16 v[160:175], a[196:199], v[232:235], v[160:175]
    ds_read_b128 v[232:235], v21 offset:53248
    s_waitcnt lgkmcnt(3)
    v_mfma_f32_32x32x16_bf16 v[96:111], a[200:203], v[236:239], v[96:111]
    s_mov_b32 s62, 120832
    buffer_load_dwordx4 a[52:55], v27, s[44:47], s62 offen
    v_mfma_f32_32x32x16_bf16 v[160:175], a[204:207], v[236:239], v[160:175]
    ds_read_b128 v[236:239], v22 offset:53248
    s_waitcnt lgkmcnt(3)
    v_mfma_f32_32x32x16_bf16 v[96:111], a[208:211], v[240:243], v[96:111]
    s_mov_b32 s62, 7168
    buffer_load_dwordx4 a[56:59], v27, s[44:47], s62 offen
    v_mfma_f32_32x32x16_bf16 v[160:175], a[212:215], v[240:243], v[160:175]
    v_and_b32 v76, v80, v13
    v_and_b32 v77, v80, v14
    ds_read_b128 v[240:243], v23 offset:53248
    s_waitcnt lgkmcnt(3)
    v_mfma_f32_32x32x16_bf16 v[96:111], a[216:219], v[244:247], v[96:111]
    s_mov_b32 s62, 121856
    buffer_load_dwordx4 a[60:63], v27, s[44:47], s62 offen
    v_mfma_f32_32x32x16_bf16 v[160:175], a[220:223], v[244:247], v[160:175]
    v_mfma_f32_32x32x16_bf16 v[96:111], v[68:71], v[76:79], v[96:111]
    v_mfma_f32_32x32x16_bf16 v[160:175], v[72:75], v[76:79], v[160:175]
    ds_read_b128 v[244:247], v24 offset:53248
    s_waitcnt lgkmcnt(3)
    v_mfma_f32_32x32x16_bf16 v[112:127], a[96:99], v[232:235], v[112:127]
    s_mov_b32 s62, 8192
    buffer_load_dwordx4 a[64:67], v27, s[44:47], s62 offen
    v_mfma_f32_32x32x16_bf16 v[176:191], a[100:103], v[232:235], v[176:191]
    ds_read_b128 v[232:235], v30 offset:4096
    s_waitcnt lgkmcnt(3)
    v_mfma_f32_32x32x16_bf16 v[112:127], a[104:107], v[236:239], v[112:127]
    s_mov_b32 s62, 122880
    buffer_load_dwordx4 a[68:71], v27, s[44:47], s62 offen
    v_mul_f32 v96, v96, v81
    v_mul_f32 v97, v97, v81
    v_mul_f32 v98, v98, v81
    v_mfma_f32_32x32x16_bf16 v[176:191], a[108:111], v[236:239], v[176:191]
    v_exp_f32 v96, v96
    v_mul_f32 v99, v99, v81
    v_exp_f32 v97, v97
    ds_read_b128 v[236:239], v31 offset:4096
    s_waitcnt lgkmcnt(3)
    v_mfma_f32_32x32x16_bf16 v[112:127], a[112:115], v[240:243], v[112:127]
    s_mov_b32 s62, 9216
    buffer_load_dwordx4 a[72:75], v27, s[44:47], s62 offen
    v_mul_f32 v100, v100, v81
    v_exp_f32 v98, v98
    v_mul_f32 v101, v101, v81
    v_mfma_f32_32x32x16_bf16 v[176:191], a[116:119], v[240:243], v[176:191]
    v_fma_f32 v96, v96, v82, v82
    v_exp_f32 v99, v99
    v_mul_f32 v102, v102, v81
    v_fma_f32 v97, v97, v82, v82
    ds_read_b128 v[240:243], v16 offset:4096
    s_waitcnt lgkmcnt(3)
    v_mfma_f32_32x32x16_bf16 v[112:127], a[120:123], v[244:247], v[112:127]
    s_mov_b32 s62, 123904
    buffer_load_dwordx4 a[76:79], v27, s[44:47], s62 offen
    v_exp_f32 v100, v100
    v_mul_f32 v103, v103, v81
    v_fma_f32 v98, v98, v82, v82
    v_mfma_f32_32x32x16_bf16 v[176:191], a[124:127], v[244:247], v[176:191]
    v_exp_f32 v101, v101
    v_mul_f32 v104, v104, v81
    v_rcp_f32 v96, v96
    ds_read_b128 v[244:247], v18 offset:4096
    s_waitcnt lgkmcnt(3)
    v_mfma_f32_32x32x16_bf16 v[112:127], a[128:131], v[232:235], v[112:127]
    s_mov_b32 s62, 10240
    buffer_load_dwordx4 a[80:83], v27, s[44:47], s62 offen
    v_fma_f32 v99, v99, v82, v82
    v_exp_f32 v102, v102
    v_mul_f32 v105, v105, v81
    v_mfma_f32_32x32x16_bf16 v[176:191], a[132:135], v[232:235], v[176:191]
    v_rcp_f32 v97, v97
    v_fma_f32 v100, v100, v82, v82
    v_exp_f32 v103, v103
    ds_read_b128 v[232:235], v30 offset:20480
    s_waitcnt lgkmcnt(3)
    v_mfma_f32_32x32x16_bf16 v[112:127], a[136:139], v[236:239], v[112:127]
    s_mov_b32 s62, 124928
    buffer_load_dwordx4 a[84:87], v27, s[44:47], s62 offen
    v_mul_f32 v106, v106, v81
    v_rcp_f32 v98, v98
    v_fma_f32 v101, v101, v82, v82
    v_mfma_f32_32x32x16_bf16 v[176:191], a[140:143], v[236:239], v[176:191]
    v_exp_f32 v104, v104
    v_mul_f32 v107, v107, v81
    v_mul_f32 v160, v160, v96
    ds_read_b128 v[236:239], v31 offset:20480
    s_waitcnt lgkmcnt(3)
    v_mfma_f32_32x32x16_bf16 v[112:127], a[144:147], v[240:243], v[112:127]
    s_mov_b32 s62, 11264
    buffer_load_dwordx4 a[88:91], v27, s[44:47], s62 offen
    v_rcp_f32 v99, v99
    v_fma_f32 v102, v102, v82, v82
    v_mfma_f32_32x32x16_bf16 v[176:191], a[148:151], v[240:243], v[176:191]
    v_exp_f32 v105, v105
    v_mul_f32 v108, v108, v81
    v_mul_f32 v161, v161, v97
    ds_read_b128 v[240:243], v16 offset:20480
    s_waitcnt lgkmcnt(3)
    v_mfma_f32_32x32x16_bf16 v[112:127], a[152:155], v[244:247], v[112:127]
    s_mov_b32 s62, 125952
    buffer_load_dwordx4 a[92:95], v27, s[44:47], s62 offen
    v_rcp_f32 v100, v100
    v_fma_f32 v103, v103, v82, v82
    v_mfma_f32_32x32x16_bf16 v[176:191], a[156:159], v[244:247], v[176:191]
    v_exp_f32 v106, v106
    v_mul_f32 v109, v109, v81
    v_mul_f32 v162, v162, v98
    ds_read_b128 v[244:247], v18 offset:20480
    s_waitcnt lgkmcnt(3)
    v_mfma_f32_32x32x16_bf16 v[112:127], a[160:163], v[232:235], v[112:127]
    v_rcp_f32 v101, v101
    v_fma_f32 v104, v104, v82, v82
    v_exp_f32 v107, v107
    v_mul_f32 v110, v110, v81
    v_mfma_f32_32x32x16_bf16 v[176:191], a[164:167], v[232:235], v[176:191]
    v_cvt_pk_bf16_f32 v224, v160, v161
    v_mul_f32 v163, v163, v99
    v_rcp_f32 v102, v102
    v_fma_f32 v105, v105, v82, v82
    ds_read_b128 v[232:235], v30 offset:36864
    s_waitcnt lgkmcnt(3)
    v_mfma_f32_32x32x16_bf16 v[112:127], a[168:171], v[236:239], v[112:127]
    v_exp_f32 v108, v108
    v_mul_f32 v111, v111, v81
    v_mul_f32 v164, v164, v100
    v_rcp_f32 v103, v103
    v_mfma_f32_32x32x16_bf16 v[176:191], a[172:175], v[236:239], v[176:191]
    v_fma_f32 v106, v106, v82, v82
    v_exp_f32 v109, v109
    v_cvt_pk_bf16_f32 v225, v162, v163
    v_mul_f32 v165, v165, v101
    ds_read_b128 v[236:239], v31 offset:36864
    s_waitcnt lgkmcnt(3)
    v_mfma_f32_32x32x16_bf16 v[112:127], a[176:179], v[240:243], v[112:127]
    v_rcp_f32 v104, v104
    v_fma_f32 v107, v107, v82, v82
    v_exp_f32 v110, v110
    v_mul_f32 v166, v166, v102
    v_mfma_f32_32x32x16_bf16 v[176:191], a[180:183], v[240:243], v[176:191]
    v_rcp_f32 v105, v105
    v_fma_f32 v108, v108, v82, v82
    v_exp_f32 v111, v111
    ds_read_b128 v[240:243], v16 offset:36864
    s_waitcnt lgkmcnt(3)
    v_mfma_f32_32x32x16_bf16 v[112:127], a[184:187], v[244:247], v[112:127]
    v_cvt_pk_bf16_f32 v226, v164, v165
    v_mul_f32 v167, v167, v103
    v_rcp_f32 v106, v106
    v_fma_f32 v109, v109, v82, v82
    v_mul_f32 v168, v168, v104
    v_mfma_f32_32x32x16_bf16 v[176:191], a[188:191], v[244:247], v[176:191]
    v_rcp_f32 v107, v107
    v_fma_f32 v110, v110, v82, v82
    v_cvt_pk_bf16_f32 v227, v166, v167
    v_mul_f32 v169, v169, v105
    ds_read_b128 v[244:247], v18 offset:36864
    s_waitcnt lgkmcnt(3)
    v_mfma_f32_32x32x16_bf16 v[112:127], a[192:195], v[232:235], v[112:127]
    v_rcp_f32 v108, v108
    v_fma_f32 v111, v111, v82, v82
    v_mul_f32 v170, v170, v106
    v_rcp_f32 v109, v109
    v_mfma_f32_32x32x16_bf16 v[176:191], a[196:199], v[232:235], v[176:191]
    v_cvt_pk_bf16_f32 v228, v168, v169
    v_mul_f32 v171, v171, v107
    v_rcp_f32 v110, v110
    v_mul_f32 v172, v172, v108
    ds_read_b128 v[232:235], v21 offset:57344
    s_waitcnt lgkmcnt(3)
    v_mfma_f32_32x32x16_bf16 v[112:127], a[200:203], v[236:239], v[112:127]
    v_rcp_f32 v111, v111
    v_cvt_pk_bf16_f32 v229, v170, v171
    v_mul_f32 v173, v173, v109
    v_mul_f32 v174, v174, v110
    v_cvt_pk_bf16_f32 v230, v172, v173
    v_mfma_f32_32x32x16_bf16 v[176:191], a[204:207], v[236:239], v[176:191]
    v_mul_f32 v175, v175, v111
    v_cvt_pk_bf16_f32 v231, v174, v175
    s_mov_b32 s63, 0
    buffer_store_dwordx4 v[224:227], v15, s[24:27], s63 offen sc0 sc1
    ds_read_b128 v[236:239], v22 offset:57344
    s_waitcnt lgkmcnt(3)
    v_mfma_f32_32x32x16_bf16 v[112:127], a[208:211], v[240:243], v[112:127]
    buffer_store_dwordx4 v[228:231], v15, s[24:27], s63 offen offset:1024 sc0 sc1
    v_mfma_f32_32x32x16_bf16 v[176:191], a[212:215], v[240:243], v[176:191]
    v_and_b32 v76, v84, v13
    v_and_b32 v77, v84, v14
    ds_read_b128 v[240:243], v23 offset:57344
    s_waitcnt lgkmcnt(3)
    v_mfma_f32_32x32x16_bf16 v[112:127], a[216:219], v[244:247], v[112:127]
    v_mfma_f32_32x32x16_bf16 v[176:191], a[220:223], v[244:247], v[176:191]
    v_mfma_f32_32x32x16_bf16 v[112:127], v[68:71], v[76:79], v[112:127]
    v_mfma_f32_32x32x16_bf16 v[176:191], v[72:75], v[76:79], v[176:191]
    ds_read_b128 v[244:247], v24 offset:57344
    s_waitcnt lgkmcnt(3)
    v_mfma_f32_32x32x16_bf16 v[128:143], a[96:99], v[232:235], v[128:143]
    v_mfma_f32_32x32x16_bf16 v[192:207], a[100:103], v[232:235], v[192:207]
    ds_read_b128 v[232:235], v30 offset:8192
    s_waitcnt lgkmcnt(3)
    v_mfma_f32_32x32x16_bf16 v[128:143], a[104:107], v[236:239], v[128:143]
    s_nop 3
    v_mul_f32 v112, v112, v85
    v_mul_f32 v113, v113, v85
    v_mul_f32 v114, v114, v85
    v_exp_f32 v112, v112
    v_mul_f32 v115, v115, v85
    v_mfma_f32_32x32x16_bf16 v[192:207], a[108:111], v[236:239], v[192:207]
    v_exp_f32 v113, v113
    v_mul_f32 v116, v116, v85
    v_exp_f32 v114, v114
    ds_read_b128 v[236:239], v31 offset:8192
    s_waitcnt lgkmcnt(3)
    v_mfma_f32_32x32x16_bf16 v[128:143], a[112:115], v[240:243], v[128:143]
    v_mul_f32 v117, v117, v85
    v_fma_f32 v112, v112, v86, v86
    v_exp_f32 v115, v115
    v_mul_f32 v118, v118, v85
    v_fma_f32 v113, v113, v86, v86
    v_mfma_f32_32x32x16_bf16 v[192:207], a[116:119], v[240:243], v[192:207]
    v_exp_f32 v116, v116
    v_mul_f32 v119, v119, v85
    v_fma_f32 v114, v114, v86, v86
    ds_read_b128 v[240:243], v16 offset:8192
    s_waitcnt lgkmcnt(3)
    v_mfma_f32_32x32x16_bf16 v[128:143], a[120:123], v[244:247], v[128:143]
    v_exp_f32 v117, v117
    v_mul_f32 v120, v120, v85
    v_rcp_f32 v112, v112
    v_fma_f32 v115, v115, v86, v86
    v_mfma_f32_32x32x16_bf16 v[192:207], a[124:127], v[244:247], v[192:207]
    v_exp_f32 v118, v118
    v_mul_f32 v121, v121, v85
    v_rcp_f32 v113, v113
    ds_read_b128 v[244:247], v18 offset:8192
    s_waitcnt lgkmcnt(3)
    v_mfma_f32_32x32x16_bf16 v[128:143], a[128:131], v[232:235], v[128:143]
    v_fma_f32 v116, v116, v86, v86
    v_exp_f32 v119, v119
    v_mul_f32 v122, v122, v85
    v_rcp_f32 v114, v114
    v_mfma_f32_32x32x16_bf16 v[192:207], a[132:135], v[232:235], v[192:207]
    v_fma_f32 v117, v117, v86, v86
    v_exp_f32 v120, v120
    v_mul_f32 v123, v123, v85
    v_mul_f32 v176, v176, v112
    ds_read_b128 v[232:235], v30 offset:24576
    s_waitcnt lgkmcnt(3)
    v_mfma_f32_32x32x16_bf16 v[128:143], a[136:139], v[236:239], v[128:143]
    v_rcp_f32 v115, v115
    v_fma_f32 v118, v118, v86, v86
    v_exp_f32 v121, v121
    v_mul_f32 v124, v124, v85
    v_mfma_f32_32x32x16_bf16 v[192:207], a[140:143], v[236:239], v[192:207]
    v_mul_f32 v177, v177, v113
    v_rcp_f32 v116, v116
    v_fma_f32 v119, v119, v86, v86
    ds_read_b128 v[236:239], v31 offset:24576
    s_waitcnt lgkmcnt(3)
    v_mfma_f32_32x32x16_bf16 v[128:143], a[144:147], v[240:243], v[128:143]
    v_exp_f32 v122, v122
    v_mul_f32 v125, v125, v85
    v_mul_f32 v178, v178, v114
    v_rcp_f32 v117, v117
    v_mfma_f32_32x32x16_bf16 v[192:207], a[148:151], v[240:243], v[192:207]
    v_fma_f32 v120, v120, v86, v86
    v_exp_f32 v123, v123
    v_mul_f32 v126, v126, v85
    v_cvt_pk_bf16_f32 v224, v176, v177
    ds_read_b128 v[240:243], v16 offset:24576
    s_waitcnt lgkmcnt(3)
    v_mfma_f32_32x32x16_bf16 v[128:143], a[152:155], v[244:247], v[128:143]
    v_mul_f32 v179, v179, v115
    v_rcp_f32 v118, v118
    v_fma_f32 v121, v121, v86, v86
    v_exp_f32 v124, v124
    v_mfma_f32_32x32x16_bf16 v[192:207], a[156:159], v[244:247], v[192:207]
    v_mul_f32 v127, v127, v85
    v_mul_f32 v180, v180, v116
    v_rcp_f32 v119, v119
    v_fma_f32 v122, v122, v86, v86
    ds_read_b128 v[244:247], v18 offset:24576
    s_waitcnt lgkmcnt(3)
    v_mfma_f32_32x32x16_bf16 v[128:143], a[160:163], v[232:235], v[128:143]
    v_exp_f32 v125, v125
    v_cvt_pk_bf16_f32 v225, v178, v179
    v_mul_f32 v181, v181, v117
    v_rcp_f32 v120, v120
    v_mfma_f32_32x32x16_bf16 v[192:207], a[164:167], v[232:235], v[192:207]
    v_fma_f32 v123, v123, v86, v86
    v_exp_f32 v126, v126
    v_mul_f32 v182, v182, v118
    ds_read_b128 v[232:235], v30 offset:40960
    s_waitcnt lgkmcnt(3)
    v_mfma_f32_32x32x16_bf16 v[128:143], a[168:171], v[236:239], v[128:143]
    v_rcp_f32 v121, v121
    v_fma_f32 v124, v124, v86, v86
    v_exp_f32 v127, v127
    v_cvt_pk_bf16_f32 v226, v180, v181
    v_mfma_f32_32x32x16_bf16 v[192:207], a[172:175], v[236:239], v[192:207]
    v_mul_f32 v183, v183, v119
    v_rcp_f32 v122, v122
    v_fma_f32 v125, v125, v86, v86
    v_mul_f32 v184, v184, v120
    ds_read_b128 v[236:239], v31 offset:40960
    s_waitcnt lgkmcnt(3)
    v_mfma_f32_32x32x16_bf16 v[128:143], a[176:179], v[240:243], v[128:143]
    v_rcp_f32 v123, v123
    v_fma_f32 v126, v126, v86, v86
    v_cvt_pk_bf16_f32 v227, v182, v183
    v_mul_f32 v185, v185, v121
    v_mfma_f32_32x32x16_bf16 v[192:207], a[180:183], v[240:243], v[192:207]
    v_rcp_f32 v124, v124
    v_fma_f32 v127, v127, v86, v86
    v_mul_f32 v186, v186, v122
    ds_read_b128 v[240:243], v16 offset:40960
    s_waitcnt lgkmcnt(3)
    v_mfma_f32_32x32x16_bf16 v[128:143], a[184:187], v[244:247], v[128:143]
    v_rcp_f32 v125, v125
    v_cvt_pk_bf16_f32 v228, v184, v185
    v_mul_f32 v187, v187, v123
    v_rcp_f32 v126, v126
    v_mfma_f32_32x32x16_bf16 v[192:207], a[188:191], v[244:247], v[192:207]
    v_mul_f32 v188, v188, v124
    v_rcp_f32 v127, v127
    v_cvt_pk_bf16_f32 v229, v186, v187
    v_mul_f32 v189, v189, v125
    ds_read_b128 v[244:247], v18 offset:40960
    s_waitcnt lgkmcnt(3)
    v_mfma_f32_32x32x16_bf16 v[128:143], a[192:195], v[232:235], v[128:143]
    v_mul_f32 v190, v190, v126
    v_cvt_pk_bf16_f32 v230, v188, v189
    v_mul_f32 v191, v191, v127
    v_cvt_pk_bf16_f32 v231, v190, v191
    s_mov_b32 s63, 114688
    v_mfma_f32_32x32x16_bf16 v[192:207], a[196:199], v[232:235], v[192:207]
    buffer_store_dwordx4 v[224:227], v15, s[24:27], s63 offen sc0 sc1
    buffer_store_dwordx4 v[228:231], v15, s[24:27], s63 offen offset:1024 sc0 sc1
    ds_read_b128 v[232:235], v21 offset:61440
    s_waitcnt lgkmcnt(3)
    v_mfma_f32_32x32x16_bf16 v[128:143], a[200:203], v[236:239], v[128:143]
    v_mfma_f32_32x32x16_bf16 v[192:207], a[204:207], v[236:239], v[192:207]
    ds_read_b128 v[236:239], v22 offset:61440
    s_waitcnt lgkmcnt(3)
    v_mfma_f32_32x32x16_bf16 v[128:143], a[208:211], v[240:243], v[128:143]
    v_mfma_f32_32x32x16_bf16 v[192:207], a[212:215], v[240:243], v[192:207]
    v_and_b32 v76, v88, v13
    v_and_b32 v77, v88, v14
    ds_read_b128 v[240:243], v23 offset:61440
    s_waitcnt lgkmcnt(3)
    v_mfma_f32_32x32x16_bf16 v[128:143], a[216:219], v[244:247], v[128:143]
    v_mfma_f32_32x32x16_bf16 v[192:207], a[220:223], v[244:247], v[192:207]
    v_mfma_f32_32x32x16_bf16 v[128:143], v[68:71], v[76:79], v[128:143]
    v_mfma_f32_32x32x16_bf16 v[192:207], v[72:75], v[76:79], v[192:207]
    ds_read_b128 v[244:247], v24 offset:61440
    s_waitcnt lgkmcnt(3)
    v_mfma_f32_32x32x16_bf16 v[144:159], a[96:99], v[232:235], v[144:159]
    v_mfma_f32_32x32x16_bf16 v[208:223], a[100:103], v[232:235], v[208:223]
    ds_read_b128 v[232:235], v30 offset:12288
    s_waitcnt lgkmcnt(3)
    v_mfma_f32_32x32x16_bf16 v[144:159], a[104:107], v[236:239], v[144:159]
    s_mov_b32 s62, 12288
    buffer_load_dwordx4 a[96:99], v27, s[44:47], s62 offen
    s_mov_b32 s62, 126976
    buffer_load_dwordx4 a[100:103], v27, s[44:47], s62 offen
    v_mul_f32 v128, v128, v89
    v_mul_f32 v129, v129, v89
    v_mul_f32 v130, v130, v89
    v_mfma_f32_32x32x16_bf16 v[208:223], a[108:111], v[236:239], v[208:223]
    v_exp_f32 v128, v128
    v_mul_f32 v131, v131, v89
    v_exp_f32 v129, v129
    ds_read_b128 v[236:239], v31 offset:12288
    s_waitcnt lgkmcnt(3)
    v_mfma_f32_32x32x16_bf16 v[144:159], a[112:115], v[240:243], v[144:159]
    s_mov_b32 s62, 13312
    buffer_load_dwordx4 a[104:107], v27, s[44:47], s62 offen
    s_mov_b32 s62, 128000
    buffer_load_dwordx4 a[108:111], v27, s[44:47], s62 offen
    v_mul_f32 v132, v132, v89
    v_exp_f32 v130, v130
    v_mul_f32 v133, v133, v89
    v_mfma_f32_32x32x16_bf16 v[208:223], a[116:119], v[240:243], v[208:223]
    v_fma_f32 v128, v128, v90, v90
    v_exp_f32 v131, v131
    v_mul_f32 v134, v134, v89
    v_fma_f32 v129, v129, v90, v90
    ds_read_b128 v[240:243], v16 offset:12288
    s_waitcnt lgkmcnt(3)
    v_mfma_f32_32x32x16_bf16 v[144:159], a[120:123], v[244:247], v[144:159]
    v_exp_f32 v132, v132
    v_mul_f32 v135, v135, v89
    v_fma_f32 v130, v130, v90, v90
    v_exp_f32 v133, v133
    v_mfma_f32_32x32x16_bf16 v[208:223], a[124:127], v[244:247], v[208:223]
    v_mul_f32 v136, v136, v89
    v_rcp_f32 v128, v128
    v_fma_f32 v131, v131, v90, v90
    ds_read_b128 v[244:247], v18 offset:12288
    s_waitcnt lgkmcnt(3)
    v_mfma_f32_32x32x16_bf16 v[144:159], a[128:131], v[232:235], v[144:159]
    v_exp_f32 v134, v134
    v_mul_f32 v137, v137, v89
    v_rcp_f32 v129, v129
    v_fma_f32 v132, v132, v90, v90
    v_mfma_f32_32x32x16_bf16 v[208:223], a[132:135], v[232:235], v[208:223]
    v_exp_f32 v135, v135
    v_mul_f32 v138, v138, v89
    v_rcp_f32 v130, v130
    ds_read_b128 v[232:235], v30 offset:28672
    s_waitcnt lgkmcnt(3)
    v_mfma_f32_32x32x16_bf16 v[144:159], a[136:139], v[236:239], v[144:159]
    v_fma_f32 v133, v133, v90, v90
    v_exp_f32 v136, v136
    v_mul_f32 v139, v139, v89
    v_mul_f32 v192, v192, v128
    v_mfma_f32_32x32x16_bf16 v[208:223], a[140:143], v[236:239], v[208:223]
    v_rcp_f32 v131, v131
    v_fma_f32 v134, v134, v90, v90
    v_exp_f32 v137, v137
    ds_read_b128 v[236:239], v31 offset:28672
    s_waitcnt lgkmcnt(3)
    v_mfma_f32_32x32x16_bf16 v[144:159], a[144:147], v[240:243], v[144:159]
    s_waitcnt vmcnt(4)
    s_barrier
    v_mov_b32 v35, 1
    s_add_u32 s62, s54, 65536
    buffer_store_dword v35, v28, s[56:59], s62 offen sc0 sc1
    v_mul_f32 v140, v140, v89
    v_mul_f32 v193, v193, v129
    v_rcp_f32 v132, v132
    v_mfma_f32_32x32x16_bf16 v[208:223], a[148:151], v[240:243], v[208:223]
    v_fma_f32 v135, v135, v90, v90
    v_exp_f32 v138, v138
    v_mul_f32 v141, v141, v89
    v_mul_f32 v194, v194, v130
    ds_read_b128 v[240:243], v16 offset:28672
    s_waitcnt lgkmcnt(3)
    v_mfma_f32_32x32x16_bf16 v[144:159], a[152:155], v[244:247], v[144:159]
    v_rcp_f32 v133, v133
    v_fma_f32 v136, v136, v90, v90
    v_exp_f32 v139, v139
    v_mul_f32 v142, v142, v89
    v_mfma_f32_32x32x16_bf16 v[208:223], a[156:159], v[244:247], v[208:223]
    v_cvt_pk_bf16_f32 v224, v192, v193
    v_mul_f32 v195, v195, v131
    v_rcp_f32 v134, v134
    v_fma_f32 v137, v137, v90, v90
    ds_read_b128 v[244:247], v18 offset:28672
    s_waitcnt lgkmcnt(3)
    v_mfma_f32_32x32x16_bf16 v[144:159], a[160:163], v[232:235], v[144:159]
    v_exp_f32 v140, v140
    v_mul_f32 v143, v143, v89
    v_mul_f32 v196, v196, v132
    v_rcp_f32 v135, v135
    v_mfma_f32_32x32x16_bf16 v[208:223], a[164:167], v[232:235], v[208:223]
    v_fma_f32 v138, v138, v90, v90
    v_exp_f32 v141, v141
    v_cvt_pk_bf16_f32 v225, v194, v195
    v_mul_f32 v197, v197, v133
    ds_read_b128 v[232:235], v30 offset:45056
    s_waitcnt lgkmcnt(3)
    v_mfma_f32_32x32x16_bf16 v[144:159], a[168:171], v[236:239], v[144:159]
    v_rcp_f32 v136, v136
    v_fma_f32 v139, v139, v90, v90
    v_exp_f32 v142, v142
    v_mul_f32 v198, v198, v134
    v_mfma_f32_32x32x16_bf16 v[208:223], a[172:175], v[236:239], v[208:223]
    v_rcp_f32 v137, v137
    v_fma_f32 v140, v140, v90, v90
    v_exp_f32 v143, v143
    ds_read_b128 v[236:239], v31 offset:45056
    s_waitcnt lgkmcnt(3)
    v_mfma_f32_32x32x16_bf16 v[144:159], a[176:179], v[240:243], v[144:159]
    v_cvt_pk_bf16_f32 v226, v196, v197
    v_mul_f32 v199, v199, v135
    v_rcp_f32 v138, v138
    v_fma_f32 v141, v141, v90, v90
    v_mul_f32 v200, v200, v136
    v_mfma_f32_32x32x16_bf16 v[208:223], a[180:183], v[240:243], v[208:223]
    v_rcp_f32 v139, v139
    v_fma_f32 v142, v142, v90, v90
    v_cvt_pk_bf16_f32 v227, v198, v199
    v_mul_f32 v201, v201, v137
    ds_read_b128 v[240:243], v16 offset:45056
    s_waitcnt lgkmcnt(3)
    v_mfma_f32_32x32x16_bf16 v[144:159], a[184:187], v[244:247], v[144:159]
    v_rcp_f32 v140, v140
    v_fma_f32 v143, v143, v90, v90
    v_mul_f32 v202, v202, v138
    v_rcp_f32 v141, v141
    v_mfma_f32_32x32x16_bf16 v[208:223], a[188:191], v[244:247], v[208:223]
    v_cvt_pk_bf16_f32 v228, v200, v201
    v_mul_f32 v203, v203, v139
    v_rcp_f32 v142, v142
    v_mul_f32 v204, v204, v140
    ds_read_b128 v[244:247], v18 offset:45056
    s_waitcnt lgkmcnt(3)
    v_mfma_f32_32x32x16_bf16 v[144:159], a[192:195], v[232:235], v[144:159]
    v_rcp_f32 v143, v143
    v_cvt_pk_bf16_f32 v229, v202, v203
    v_mul_f32 v205, v205, v141
    v_mul_f32 v206, v206, v142
    v_cvt_pk_bf16_f32 v230, v204, v205
    v_mfma_f32_32x32x16_bf16 v[208:223], a[196:199], v[232:235], v[208:223]
    v_mul_f32 v207, v207, v143
    v_cvt_pk_bf16_f32 v231, v206, v207
    s_mov_b32 s63, 229376
    buffer_store_dwordx4 v[224:227], v15, s[24:27], s63 offen sc0 sc1
    s_waitcnt lgkmcnt(2)
    v_mfma_f32_32x32x16_bf16 v[144:159], a[200:203], v[236:239], v[144:159]
    buffer_store_dwordx4 v[228:231], v15, s[24:27], s63 offen offset:1024 sc0 sc1
    v_mfma_f32_32x32x16_bf16 v[208:223], a[204:207], v[236:239], v[208:223]
    s_waitcnt lgkmcnt(1)
    v_mfma_f32_32x32x16_bf16 v[144:159], a[208:211], v[240:243], v[144:159]
    v_mfma_f32_32x32x16_bf16 v[208:223], a[212:215], v[240:243], v[208:223]
    v_and_b32 v76, v92, v13
    v_and_b32 v77, v92, v14
    s_waitcnt lgkmcnt(0)
    v_mfma_f32_32x32x16_bf16 v[144:159], a[216:219], v[244:247], v[144:159]
    v_mfma_f32_32x32x16_bf16 v[208:223], a[220:223], v[244:247], v[208:223]
    v_mfma_f32_32x32x16_bf16 v[144:159], v[68:71], v[76:79], v[144:159]
    v_mfma_f32_32x32x16_bf16 v[208:223], v[72:75], v[76:79], v[208:223]
    s_nop 10
    v_pk_mul_f32 v[144:145], v[144:145], v[92:93] op_sel:[0,1] op_sel_hi:[1,1]
    v_pk_mul_f32 v[146:147], v[146:147], v[92:93] op_sel:[0,1] op_sel_hi:[1,1]
    v_pk_mul_f32 v[148:149], v[148:149], v[92:93] op_sel:[0,1] op_sel_hi:[1,1]
    v_pk_mul_f32 v[150:151], v[150:151], v[92:93] op_sel:[0,1] op_sel_hi:[1,1]
    v_pk_mul_f32 v[152:153], v[152:153], v[92:93] op_sel:[0,1] op_sel_hi:[1,1]
    v_pk_mul_f32 v[154:155], v[154:155], v[92:93] op_sel:[0,1] op_sel_hi:[1,1]
    v_pk_mul_f32 v[156:157], v[156:157], v[92:93] op_sel:[0,1] op_sel_hi:[1,1]
    v_pk_mul_f32 v[158:159], v[158:159], v[92:93] op_sel:[0,1] op_sel_hi:[1,1]
    v_exp_f32 v144, v144
    v_exp_f32 v145, v145
    v_exp_f32 v146, v146
    v_exp_f32 v147, v147
    v_exp_f32 v148, v148
    v_exp_f32 v149, v149
    v_exp_f32 v150, v150
    v_exp_f32 v151, v151
    v_exp_f32 v152, v152
    v_exp_f32 v153, v153
    v_exp_f32 v154, v154
    v_exp_f32 v155, v155
    v_exp_f32 v156, v156
    v_exp_f32 v157, v157
    v_exp_f32 v158, v158
    v_exp_f32 v159, v159
    v_pk_fma_f32 v[144:145], v[144:145], v[94:95], v[94:95] op_sel_hi:[1,0,0]
    v_pk_fma_f32 v[146:147], v[146:147], v[94:95], v[94:95] op_sel_hi:[1,0,0]
    v_pk_fma_f32 v[148:149], v[148:149], v[94:95], v[94:95] op_sel_hi:[1,0,0]
    v_pk_fma_f32 v[150:151], v[150:151], v[94:95], v[94:95] op_sel_hi:[1,0,0]
    v_pk_fma_f32 v[152:153], v[152:153], v[94:95], v[94:95] op_sel_hi:[1,0,0]
    v_pk_fma_f32 v[154:155], v[154:155], v[94:95], v[94:95] op_sel_hi:[1,0,0]
    v_pk_fma_f32 v[156:157], v[156:157], v[94:95], v[94:95] op_sel_hi:[1,0,0]
    v_pk_fma_f32 v[158:159], v[158:159], v[94:95], v[94:95] op_sel_hi:[1,0,0]
    v_rcp_f32 v144, v144
    v_rcp_f32 v145, v145
    v_rcp_f32 v146, v146
    v_rcp_f32 v147, v147
    v_rcp_f32 v148, v148
    v_rcp_f32 v149, v149
    v_rcp_f32 v150, v150
    v_rcp_f32 v151, v151
    v_rcp_f32 v152, v152
    v_rcp_f32 v153, v153
    v_rcp_f32 v154, v154
    v_rcp_f32 v155, v155
    v_rcp_f32 v156, v156
    v_rcp_f32 v157, v157
    v_rcp_f32 v158, v158
    v_rcp_f32 v159, v159
    v_pk_mul_f32 v[208:209], v[208:209], v[144:145]
    v_pk_mul_f32 v[210:211], v[210:211], v[146:147]
    v_pk_mul_f32 v[212:213], v[212:213], v[148:149]
    v_pk_mul_f32 v[214:215], v[214:215], v[150:151]
    v_pk_mul_f32 v[216:217], v[216:217], v[152:153]
    v_pk_mul_f32 v[218:219], v[218:219], v[154:155]
    v_pk_mul_f32 v[220:221], v[220:221], v[156:157]
    v_pk_mul_f32 v[222:223], v[222:223], v[158:159]
    v_cvt_pk_bf16_f32 v224, v208, v209
    v_cvt_pk_bf16_f32 v225, v210, v211
    v_cvt_pk_bf16_f32 v226, v212, v213
    v_cvt_pk_bf16_f32 v227, v214, v215
    v_cvt_pk_bf16_f32 v228, v216, v217
    v_cvt_pk_bf16_f32 v229, v218, v219
    v_cvt_pk_bf16_f32 v230, v220, v221
    v_cvt_pk_bf16_f32 v231, v222, v223
    s_mov_b32 s63, 344064
    buffer_store_dwordx4 v[224:227], v15, s[24:27], s63 offen sc0 sc1
    buffer_store_dwordx4 v[228:231], v15, s[24:27], s63 offen offset:1024 sc0 sc1
    s_add_u32 s62, s55, 65536
    buffer_load_dword v32, v29, s[56:59], s62 offen sc0 sc1
    s_mov_b32 s62, 27648
    buffer_load_dwordx4 a[216:219], v27, s[44:47], s62 offen
    s_mov_b32 s62, 142336
    buffer_load_dwordx4 a[220:223], v27, s[44:47], s62 offen
    s_mul_i32 s62, s3, 10240
    s_add_u32 s62, s62, 116736
    v_add_u32 v25, s62, v12
    ds_read_b128 a[176:179], v25 offset:0
    ds_read_b128 a[180:183], v25 offset:1024
    ds_read_b128 a[184:187], v25 offset:2048
    ds_read_b128 a[188:191], v25 offset:3072
    ds_read_b128 a[192:195], v25 offset:4096
    ds_read_b128 a[196:199], v25 offset:5120
    ds_read_b128 a[200:203], v25 offset:6144
    ds_read_b128 a[204:207], v25 offset:7168
    ds_read_b128 a[208:211], v25 offset:8192
    ds_read_b128 a[212:215], v25 offset:9216
    s_lshr_b32 s62, s52, 1
    s_lshl_b32 s62, s62, 2
    s_and_b32 s63, s52, 1
    s_add_u32 s4, s62, s63
    s_mul_i32 s62, s4, 114688
    s_mul_i32 s63, s3, 28672
    s_add_u32 s62, s62, s63
    v_add_u32 v21, s62, v12
    v_accvgpr_write_b32 a144, v36
    v_accvgpr_write_b32 a145, v37
    v_accvgpr_write_b32 a146, v38
    v_accvgpr_write_b32 a147, v39
    v_accvgpr_write_b32 a148, v40
    v_accvgpr_write_b32 a149, v41
    v_accvgpr_write_b32 a150, v42
    v_accvgpr_write_b32 a151, v43
    v_accvgpr_write_b32 a152, v44
    v_accvgpr_write_b32 a153, v45
    v_accvgpr_write_b32 a154, v46
    v_accvgpr_write_b32 a155, v47
    v_accvgpr_write_b32 a156, v48
    v_accvgpr_write_b32 a157, v49
    v_accvgpr_write_b32 a158, v50
    v_accvgpr_write_b32 a159, v51
    v_accvgpr_write_b32 a160, v52
    v_accvgpr_write_b32 a161, v53
    v_accvgpr_write_b32 a162, v54
    v_accvgpr_write_b32 a163, v55
    v_accvgpr_write_b32 a164, v56
    v_accvgpr_write_b32 a165, v57
    v_accvgpr_write_b32 a166, v58
    v_accvgpr_write_b32 a167, v59
    v_accvgpr_write_b32 a168, v60
    v_accvgpr_write_b32 a169, v61
    v_accvgpr_write_b32 a170, v62
    v_accvgpr_write_b32 a171, v63
    v_accvgpr_write_b32 a172, v64
    v_accvgpr_write_b32 a173, v65
    v_accvgpr_write_b32 a174, v66
    v_accvgpr_write_b32 a175, v67
    s_lshr_b32 s63, s3, 1
    s_lshl_b32 s63, s63, 6
    s_lshl_b32 s60, s53, 7
    s_add_u32 s63, s63, s60
    s_and_b32 s60, s3, 1
    s_lshl_b32 s60, s60, 5
    s_add_u32 s63, s63, s60
    v_lshl_add_u32 v5, v11, 3, s63
    v_lshlrev_b32 v4, 6, v10
    v_add_u32 v4, s4, v4
    v_mul_u32_u24 v4, 896, v4
    v_add_u32 v22, v4, v5
    s_lshl_b32 s62, s4, 5
    v_add_u32 v4, s62, v10
    v_mul_u32_u24 v4, 896, v4
    v_add_u32 v23, v4, v5
    s_lshl_b32 s62, s3, 13
    v_add_u32 v24, s62, v12
    s_lshl_b32 s62, s3, 11
    v_add_u32 v20, s62, v12
    s_waitcnt lgkmcnt(0)
    s_waitcnt vmcnt(2)
    s_mov_b32 s60, 0
FA_CHK:
    v_cmp_eq_u32 vcc, 0, v32
    s_add_u32 s60, s60, 1
    s_cmp_ge_u32 s60, 0x40000
    s_cselect_b32 s61, 0, 0x3fff
    s_cmp_eq_u32 s3, 0
    s_cselect_b32 s61, s61, 0
    s_and_b32 s61, vcc_lo, s61
    s_cbranch_scc1 FA_RETRY
    s_barrier
    v_mov_b32 v35, 1
    s_add_u32 s62, s54, 131072
    buffer_store_dword v35, v28, s[56:59], s62 offen sc0 sc1
    s_mov_b32 s62, 0
    buffer_load_dwordx4 v[96:99], v21, s[24:27], s62 offen sc0 sc1
    s_mov_b32 s62, 1024
    buffer_load_dwordx4 v[100:103], v21, s[24:27], s62 offen sc0 sc1
    s_mov_b32 s62, 2048
    buffer_load_dwordx4 v[104:107], v21, s[24:27], s62 offen sc0 sc1
    s_mov_b32 s62, 3072
    buffer_load_dwordx4 v[108:111], v21, s[24:27], s62 offen sc0 sc1
    s_mov_b32 s62, 4096
    buffer_load_dwordx4 v[112:115], v21, s[24:27], s62 offen sc0 sc1
    s_mov_b32 s62, 5120
    buffer_load_dwordx4 v[116:119], v21, s[24:27], s62 offen sc0 sc1
    s_mov_b32 s62, 6144
    buffer_load_dwordx4 v[120:123], v21, s[24:27], s62 offen sc0 sc1
    s_mov_b32 s62, 7168
    buffer_load_dwordx4 v[124:127], v21, s[24:27], s62 offen sc0 sc1
    s_mov_b32 s62, 8192
    buffer_load_dwordx4 v[128:131], v21, s[24:27], s62 offen sc0 sc1
    s_mov_b32 s62, 9216
    buffer_load_dwordx4 v[132:135], v21, s[24:27], s62 offen sc0 sc1
    s_mov_b32 s62, 10240
    buffer_load_dwordx4 v[136:139], v21, s[24:27], s62 offen sc0 sc1
    s_mov_b32 s62, 11264
    buffer_load_dwordx4 v[140:143], v21, s[24:27], s62 offen sc0 sc1
    s_mov_b32 s62, 12288
    buffer_load_dwordx4 v[160:163], v21, s[24:27], s62 offen sc0 sc1
    s_mov_b32 s62, 13312
    buffer_load_dwordx4 v[164:167], v21, s[24:27], s62 offen sc0 sc1
    s_mov_b32 s62, 14336
    buffer_load_dwordx4 v[168:171], v21, s[24:27], s62 offen sc0 sc1
    s_mov_b32 s62, 15360
    buffer_load_dwordx4 v[172:175], v21, s[24:27], s62 offen sc0 sc1
    s_mov_b32 s62, 0
    buffer_load_dwordx2 v[68:69], v23, s[20:23], s62 offen offset:0 sc0 sc1
    s_mov_b32 s62, 0
    buffer_load_dwordx2 v[70:71], v23, s[20:23], s62 offen offset:16 sc0 sc1
    s_mov_b32 s62, 57344
    buffer_load_dwordx2 v[72:73], v23, s[20:23], s62 offen offset:0 sc0 sc1
    s_mov_b32 s62, 57344
    buffer_load_dwordx2 v[74:75], v23, s[20:23], s62 offen offset:16 sc0 sc1
    s_waitcnt vmcnt(19)
    v_mfma_f32_32x32x16_bf16 v[36:51], a[0:3], v[96:99], 0
    s_mov_b32 s62, 16384
    buffer_load_dwordx4 v[176:179], v21, s[24:27], s62 offen sc0 sc1
    v_mfma_f32_32x32x16_bf16 v[52:67], a[4:7], v[96:99], 0
    s_waitcnt vmcnt(19)
    v_mfma_f32_32x32x16_bf16 v[36:51], a[8:11], v[100:103], v[36:51]
    s_mov_b32 s62, 17408
    buffer_load_dwordx4 v[180:183], v21, s[24:27], s62 offen sc0 sc1
    v_mfma_f32_32x32x16_bf16 v[52:67], a[12:15], v[100:103], v[52:67]
    s_waitcnt vmcnt(19)
    v_mfma_f32_32x32x16_bf16 v[36:51], a[16:19], v[104:107], v[36:51]
    s_mov_b32 s62, 18432
    buffer_load_dwordx4 v[184:187], v21, s[24:27], s62 offen sc0 sc1
    v_mfma_f32_32x32x16_bf16 v[52:67], a[20:23], v[104:107], v[52:67]
    s_waitcnt vmcnt(19)
    v_mfma_f32_32x32x16_bf16 v[36:51], a[24:27], v[108:111], v[36:51]
    s_mov_b32 s62, 19456
    buffer_load_dwordx4 v[188:191], v21, s[24:27], s62 offen sc0 sc1
    v_mfma_f32_32x32x16_bf16 v[52:67], a[28:31], v[108:111], v[52:67]
    s_waitcnt vmcnt(19)
    v_mfma_f32_32x32x16_bf16 v[36:51], a[32:35], v[112:115], v[36:51]
    s_mov_b32 s62, 20480
    buffer_load_dwordx4 v[192:195], v21, s[24:27], s62 offen sc0 sc1
    v_mfma_f32_32x32x16_bf16 v[52:67], a[36:39], v[112:115], v[52:67]
    s_waitcnt vmcnt(19)
    v_mfma_f32_32x32x16_bf16 v[36:51], a[40:43], v[116:119], v[36:51]
    s_mov_b32 s62, 21504
    buffer_load_dwordx4 v[196:199], v21, s[24:27], s62 offen sc0 sc1
    v_mfma_f32_32x32x16_bf16 v[52:67], a[44:47], v[116:119], v[52:67]
    s_waitcnt vmcnt(19)
    v_mfma_f32_32x32x16_bf16 v[36:51], a[48:51], v[120:123], v[36:51]
    s_mov_b32 s62, 22528
    buffer_load_dwordx4 v[200:203], v21, s[24:27], s62 offen sc0 sc1
    v_mfma_f32_32x32x16_bf16 v[52:67], a[52:55], v[120:123], v[52:67]
    s_waitcnt vmcnt(19)
    v_mfma_f32_32x32x16_bf16 v[36:51], a[56:59], v[124:127], v[36:51]
    s_mov_b32 s62, 23552
    buffer_load_dwordx4 v[204:207], v21, s[24:27], s62 offen sc0 sc1
    v_mfma_f32_32x32x16_bf16 v[52:67], a[60:63], v[124:127], v[52:67]
    s_waitcnt vmcnt(19)
    v_mfma_f32_32x32x16_bf16 v[36:51], a[64:67], v[128:131], v[36:51]
    s_mov_b32 s62, 24576
    buffer_load_dwordx4 v[96:99], v21, s[24:27], s62 offen sc0 sc1
    v_mfma_f32_32x32x16_bf16 v[52:67], a[68:71], v[128:131], v[52:67]
    s_waitcnt vmcnt(19)
    v_mfma_f32_32x32x16_bf16 v[36:51], a[72:75], v[132:135], v[36:51]
    s_mov_b32 s62, 25600
    buffer_load_dwordx4 v[100:103], v21, s[24:27], s62 offen sc0 sc1
    v_mfma_f32_32x32x16_bf16 v[52:67], a[76:79], v[132:135], v[52:67]
    s_waitcnt vmcnt(19)
    v_mfma_f32_32x32x16_bf16 v[36:51], a[80:83], v[136:139], v[36:51]
    s_mov_b32 s62, 26624
    buffer_load_dwordx4 v[104:107], v21, s[24:27], s62 offen sc0 sc1
    v_mfma_f32_32x32x16_bf16 v[52:67], a[84:87], v[136:139], v[52:67]
    s_waitcnt vmcnt(19)
    v_mfma_f32_32x32x16_bf16 v[36:51], a[88:91], v[140:143], v[36:51]
    s_mov_b32 s62, 27648
    buffer_load_dwordx4 v[108:111], v21, s[24:27], s62 offen sc0 sc1
    v_mfma_f32_32x32x16_bf16 v[52:67], a[92:95], v[140:143], v[52:67]
    s_add_u32 s62, s55, 131072
    buffer_load_dword v33, v29, s[56:59], s62 offen sc0 sc1
    s_waitcnt vmcnt(20)
    v_mfma_f32_32x32x16_bf16 v[36:51], a[96:99], v[160:163], v[36:51]
    v_mfma_f32_32x32x16_bf16 v[52:67], a[100:103], v[160:163], v[52:67]
    s_waitcnt vmcnt(19)
    v_mfma_f32_32x32x16_bf16 v[36:51], a[104:107], v[164:167], v[36:51]
    v_mfma_f32_32x32x16_bf16 v[52:67], a[108:111], v[164:167], v[52:67]
    s_waitcnt vmcnt(18)
    v_mfma_f32_32x32x16_bf16 v[36:51], a[224:227], v[168:171], v[36:51]
    v_mfma_f32_32x32x16_bf16 v[52:67], a[228:231], v[168:171], v[52:67]
    s_waitcnt vmcnt(17)
    v_mfma_f32_32x32x16_bf16 v[36:51], a[232:235], v[172:175], v[36:51]
    v_mfma_f32_32x32x16_bf16 v[52:67], a[236:239], v[172:175], v[52:67]
    s_waitcnt vmcnt(12)
    v_mfma_f32_32x32x16_bf16 v[36:51], a[240:243], v[176:179], v[36:51]
    v_mfma_f32_32x32x16_bf16 v[52:67], a[244:247], v[176:179], v[52:67]
    s_waitcnt vmcnt(11)
    v_mfma_f32_32x32x16_bf16 v[36:51], a[248:251], v[180:183], v[36:51]
    v_mfma_f32_32x32x16_bf16 v[52:67], a[252:255], v[180:183], v[52:67]
    s_waitcnt vmcnt(10)
    v_mfma_f32_32x32x16_bf16 v[36:51], a[144:147], v[184:187], v[36:51]
    v_mfma_f32_32x32x16_bf16 v[52:67], a[148:151], v[184:187], v[52:67]
    s_waitcnt vmcnt(9)
    v_mfma_f32_32x32x16_bf16 v[36:51], a[152:155], v[188:191], v[36:51]
    v_mfma_f32_32x32x16_bf16 v[52:67], a[156:159], v[188:191], v[52:67]
    s_waitcnt vmcnt(0)
    s_mov_b32 s60, 0
FB_CHK:
    v_cmp_eq_u32 vcc, 0, v33
    s_add_u32 s60, s60, 1
    s_cmp_ge_u32 s60, 0x40000
    s_cselect_b32 s61, 0, 0x3fff
    s_cmp_eq_u32 s3, 0
    s_cselect_b32 s61, s61, 0
    s_and_b32 s61, vcc_lo, s61
    s_cbranch_scc1 FB_RETRY
    s_barrier
    s_waitcnt vmcnt(8)
    v_mfma_f32_32x32x16_bf16 v[36:51], a[160:163], v[192:195], v[36:51]
    s_mov_b32 s62, 229376
    buffer_load_dwordx4 v[112:115], v21, s[24:27], s62 offen sc0 sc1
    v_mfma_f32_32x32x16_bf16 v[52:67], a[164:167], v[192:195], v[52:67]
    s_mov_b32 s62, 230400
    buffer_load_dwordx4 v[116:119], v21, s[24:27], s62 offen sc0 sc1
    s_waitcnt vmcnt(9)
    v_mfma_f32_32x32x16_bf16 v[36:51], a[168:171], v[196:199], v[36:51]
    s_mov_b32 s62, 231424
    buffer_load_dwordx4 v[120:123], v21, s[24:27], s62 offen sc0 sc1
    v_mfma_f32_32x32x16_bf16 v[52:67], a[172:175], v[196:199], v[52:67]
    s_mov_b32 s62, 232448
    buffer_load_dwordx4 v[124:127], v21, s[24:27], s62 offen sc0 sc1
    s_waitcnt vmcnt(10)
    v_mfma_f32_32x32x16_bf16 v[36:51], a[176:179], v[200:203], v[36:51]
    s_mov_b32 s62, 233472
    buffer_load_dwordx4 v[128:131], v21, s[24:27], s62 offen sc0 sc1
    v_mfma_f32_32x32x16_bf16 v[52:67], a[180:183], v[200:203], v[52:67]
    s_mov_b32 s62, 234496
    buffer_load_dwordx4 v[132:135], v21, s[24:27], s62 offen sc0 sc1
    s_waitcnt vmcnt(11)
    v_mfma_f32_32x32x16_bf16 v[36:51], a[184:187], v[204:207], v[36:51]
    s_mov_b32 s62, 235520
    buffer_load_dwordx4 v[136:139], v21, s[24:27], s62 offen sc0 sc1
    v_mfma_f32_32x32x16_bf16 v[52:67], a[188:191], v[204:207], v[52:67]
    s_mov_b32 s62, 236544
    buffer_load_dwordx4 v[140:143], v21, s[24:27], s62 offen sc0 sc1
    s_waitcnt vmcnt(12)
    v_mfma_f32_32x32x16_bf16 v[36:51], a[192:195], v[96:99], v[36:51]
    s_mov_b32 s62, 237568
    buffer_load_dwordx4 v[160:163], v21, s[24:27], s62 offen sc0 sc1
    v_mfma_f32_32x32x16_bf16 v[52:67], a[196:199], v[96:99], v[52:67]
    s_mov_b32 s62, 238592
    buffer_load_dwordx4 v[164:167], v21, s[24:27], s62 offen sc0 sc1
    s_waitcnt vmcnt(13)
    v_mfma_f32_32x32x16_bf16 v[36:51], a[200:203], v[100:103], v[36:51]
    s_mov_b32 s62, 239616
    buffer_load_dwordx4 v[168:171], v21, s[24:27], s62 offen sc0 sc1
    v_mfma_f32_32x32x16_bf16 v[52:67], a[204:207], v[100:103], v[52:67]
    s_mov_b32 s62, 240640
    buffer_load_dwordx4 v[172:175], v21, s[24:27], s62 offen sc0 sc1
    s_waitcnt vmcnt(14)
    v_mfma_f32_32x32x16_bf16 v[36:51], a[208:211], v[104:107], v[36:51]
    s_mov_b32 s62, 241664
    buffer_load_dwordx4 v[176:179], v21, s[24:27], s62 offen sc0 sc1
    v_mfma_f32_32x32x16_bf16 v[52:67], a[212:215], v[104:107], v[52:67]
    s_mov_b32 s62, 242688
    buffer_load_dwordx4 v[180:183], v21, s[24:27], s62 offen sc0 sc1
    s_waitcnt vmcnt(15)
    v_mfma_f32_32x32x16_bf16 v[36:51], a[216:219], v[108:111], v[36:51]
    s_mov_b32 s62, 243712
    buffer_load_dwordx4 v[184:187], v21, s[24:27], s62 offen sc0 sc1
    v_mfma_f32_32x32x16_bf16 v[52:67], a[220:223], v[108:111], v[52:67]
    s_waitcnt vmcnt(14)
    v_mfma_f32_32x32x16_bf16 v[144:159], a[0:3], v[112:115], 0
    s_mov_b32 s62, 244736
    buffer_load_dwordx4 v[188:191], v21, s[24:27], s62 offen sc0 sc1
    v_mfma_f32_32x32x16_bf16 v[208:223], a[4:7], v[112:115], 0
    s_waitcnt vmcnt(14)
    v_mfma_f32_32x32x16_bf16 v[144:159], a[8:11], v[116:119], v[144:159]
    s_mov_b32 s62, 245760
    buffer_load_dwordx4 v[192:195], v21, s[24:27], s62 offen sc0 sc1
    v_mfma_f32_32x32x16_bf16 v[208:223], a[12:15], v[116:119], v[208:223]
    s_waitcnt vmcnt(14)
    v_mfma_f32_32x32x16_bf16 v[144:159], a[16:19], v[120:123], v[144:159]
    s_mov_b32 s62, 246784
    buffer_load_dwordx4 v[196:199], v21, s[24:27], s62 offen sc0 sc1
    v_mfma_f32_32x32x16_bf16 v[208:223], a[20:23], v[120:123], v[208:223]
    ds_write_b128 v24, v[36:39] offset:0
    ds_write_b128 v24, v[40:43] offset:1024
    ds_write_b128 v24, v[44:47] offset:2048
    ds_write_b128 v24, v[48:51] offset:3072
    ds_write_b128 v24, v[52:55] offset:4096
    ds_write_b128 v24, v[56:59] offset:5120
    ds_write_b128 v24, v[60:63] offset:6144
    ds_write_b128 v24, v[64:67] offset:7168
    s_waitcnt vmcnt(14)
    v_mfma_f32_32x32x16_bf16 v[144:159], a[24:27], v[124:127], v[144:159]
    s_mov_b32 s62, 247808
    buffer_load_dwordx4 v[200:203], v21, s[24:27], s62 offen sc0 sc1
    v_mfma_f32_32x32x16_bf16 v[208:223], a[28:31], v[124:127], v[208:223]
    s_waitcnt vmcnt(14)
    v_mfma_f32_32x32x16_bf16 v[144:159], a[32:35], v[128:131], v[144:159]
    s_mov_b32 s62, 248832
    buffer_load_dwordx4 v[204:207], v21, s[24:27], s62 offen sc0 sc1
    v_mfma_f32_32x32x16_bf16 v[208:223], a[36:39], v[128:131], v[208:223]
    s_waitcnt vmcnt(14)
    v_mfma_f32_32x32x16_bf16 v[144:159], a[40:43], v[132:135], v[144:159]
    s_mov_b32 s62, 249856
    buffer_load_dwordx4 v[96:99], v21, s[24:27], s62 offen sc0 sc1
    v_mfma_f32_32x32x16_bf16 v[208:223], a[44:47], v[132:135], v[208:223]
    s_waitcnt vmcnt(14)
    v_mfma_f32_32x32x16_bf16 v[144:159], a[48:51], v[136:139], v[144:159]
    s_mov_b32 s62, 250880
    buffer_load_dwordx4 v[100:103], v21, s[24:27], s62 offen sc0 sc1
    v_mfma_f32_32x32x16_bf16 v[208:223], a[52:55], v[136:139], v[208:223]
    s_waitcnt lgkmcnt(0)
    s_barrier
    s_waitcnt vmcnt(35)
    s_waitcnt vmcnt(14)
    v_mfma_f32_32x32x16_bf16 v[144:159], a[56:59], v[140:143], v[144:159]
    s_mov_b32 s62, 251904
    buffer_load_dwordx4 v[104:107], v21, s[24:27], s62 offen sc0 sc1
    ds_read_b128 v[36:39], v20 offset:0
    ds_read_b128 v[52:55], v20 offset:1024
    ds_read_b128 v[40:43], v20 offset:8192
    v_mfma_f32_32x32x16_bf16 v[208:223], a[60:63], v[140:143], v[208:223]
    ds_read_b128 v[56:59], v20 offset:9216
    ds_read_b128 v[44:47], v20 offset:16384
    ds_read_b128 v[60:63], v20 offset:17408
    s_waitcnt vmcnt(14)
    v_mfma_f32_32x32x16_bf16 v[144:159], a[64:67], v[160:163], v[144:159]
    s_mov_b32 s62, 252928
    buffer_load_dwordx4 v[108:111], v21, s[24:27], s62 offen sc0 sc1
    ds_read_b128 v[48:51], v20 offset:24576
    ds_read_b128 v[64:67], v20 offset:25600
    v_lshlrev_b32 v80, 16, v68
    v_mfma_f32_32x32x16_bf16 v[208:223], a[68:71], v[160:163], v[208:223]
    v_and_b32 v81, 0xffff0000, v68
    v_lshlrev_b32 v82, 16, v69
    v_and_b32 v83, 0xffff0000, v69
    s_waitcnt vmcnt(14)
    v_mfma_f32_32x32x16_bf16 v[144:159], a[72:75], v[164:167], v[144:159]
    s_mov_b32 s62, 253952
    buffer_load_dwordx4 v[112:115], v21, s[24:27], s62 offen sc0 sc1
    v_lshlrev_b32 v84, 16, v70
    v_and_b32 v85, 0xffff0000, v70
    v_lshlrev_b32 v86, 16, v71
    v_mfma_f32_32x32x16_bf16 v[208:223], a[76:79], v[164:167], v[208:223]
    v_and_b32 v87, 0xffff0000, v71
    s_waitcnt lgkmcnt(0)
    v_pk_add_f32 v[36:37], v[36:37], v[40:41]
    s_waitcnt vmcnt(14)
    v_mfma_f32_32x32x16_bf16 v[144:159], a[80:83], v[168:171], v[144:159]
    s_mov_b32 s62, 254976
    buffer_load_dwordx4 v[116:119], v21, s[24:27], s62 offen sc0 sc1
    v_pk_add_f32 v[44:45], v[44:45], v[48:49]
    v_pk_add_f32 v[38:39], v[38:39], v[42:43]
    v_pk_add_f32 v[46:47], v[46:47], v[50:51]
    v_mfma_f32_32x32x16_bf16 v[208:223], a[84:87], v[168:171], v[208:223]
    v_pk_add_f32 v[52:53], v[52:53], v[56:57]
    v_pk_add_f32 v[60:61], v[60:61], v[64:65]
    v_pk_add_f32 v[54:55], v[54:55], v[58:59]
    s_waitcnt vmcnt(14)
    v_mfma_f32_32x32x16_bf16 v[144:159], a[88:91], v[172:175], v[144:159]
    s_mov_b32 s62, 256000
    buffer_load_dwordx4 v[120:123], v21, s[24:27], s62 offen sc0 sc1
    v_pk_add_f32 v[62:63], v[62:63], v[66:67]
    v_pk_add_f32 v[36:37], v[36:37], v[44:45]
    v_pk_add_f32 v[38:39], v[38:39], v[46:47]
    v_mfma_f32_32x32x16_bf16 v[208:223], a[92:95], v[172:175], v[208:223]
    v_pk_add_f32 v[52:53], v[52:53], v[60:61]
    v_pk_add_f32 v[54:55], v[54:55], v[62:63]
    v_cvt_pk_bf16_f32 v224, v36, v37
    s_waitcnt vmcnt(14)
    v_mfma_f32_32x32x16_bf16 v[144:159], a[96:99], v[176:179], v[144:159]
    s_mov_b32 s62, 257024
    buffer_load_dwordx4 v[124:127], v21, s[24:27], s62 offen sc0 sc1
    v_cvt_pk_bf16_f32 v225, v38, v39
    v_cvt_pk_bf16_f32 v226, v52, v53
    v_cvt_pk_bf16_f32 v227, v54, v55
    v_mfma_f32_32x32x16_bf16 v[208:223], a[100:103], v[176:179], v[208:223]
    v_lshlrev_b32 v36, 16, v224
    v_and_b32 v37, 0xffff0000, v224
    v_lshlrev_b32 v38, 16, v225
    s_waitcnt vmcnt(14)
    v_mfma_f32_32x32x16_bf16 v[144:159], a[104:107], v[180:183], v[144:159]
    v_and_b32 v39, 0xffff0000, v225
    v_lshlrev_b32 v52, 16, v226
    v_and_b32 v53, 0xffff0000, v226
    v_mfma_f32_32x32x16_bf16 v[208:223], a[108:111], v[180:183], v[208:223]
    v_lshlrev_b32 v54, 16, v227
    v_and_b32 v55, 0xffff0000, v227
    v_pk_add_f32 v[36:37], v[36:37], v[80:81]
    s_waitcnt vmcnt(13)
    v_mfma_f32_32x32x16_bf16 v[144:159], a[224:227], v[184:187], v[144:159]
    v_pk_add_f32 v[38:39], v[38:39], v[82:83]
    v_pk_add_f32 v[52:53], v[52:53], v[84:85]
    v_pk_add_f32 v[54:55], v[54:55], v[86:87]
    v_mfma_f32_32x32x16_bf16 v[208:223], a[228:231], v[184:187], v[208:223]
    v_cvt_pk_bf16_f32 v228, v36, v37
    v_cvt_pk_bf16_f32 v229, v38, v39
    v_cvt_pk_bf16_f32 v230, v52, v53
    s_waitcnt vmcnt(12)
    v_mfma_f32_32x32x16_bf16 v[144:159], a[232:235], v[188:191], v[144:159]
    v_cvt_pk_bf16_f32 v231, v54, v55
    s_mov_b32 s63, 0
    buffer_store_dwordx2 v[228:229], v22, s[48:51], s63 offen offset:0
    v_mfma_f32_32x32x16_bf16 v[208:223], a[236:239], v[188:191], v[208:223]
    buffer_store_dwordx2 v[230:231], v22, s[48:51], s63 offen offset:16
    s_waitcnt vmcnt(13)
    v_mfma_f32_32x32x16_bf16 v[144:159], a[240:243], v[192:195], v[144:159]
    v_mfma_f32_32x32x16_bf16 v[208:223], a[244:247], v[192:195], v[208:223]
    s_waitcnt vmcnt(12)
    v_mfma_f32_32x32x16_bf16 v[144:159], a[248:251], v[196:199], v[144:159]
    v_mfma_f32_32x32x16_bf16 v[208:223], a[252:255], v[196:199], v[208:223]
    s_waitcnt vmcnt(11)
    v_mfma_f32_32x32x16_bf16 v[144:159], a[144:147], v[200:203], v[144:159]
    v_mfma_f32_32x32x16_bf16 v[208:223], a[148:151], v[200:203], v[208:223]
    s_waitcnt vmcnt(10)
    v_mfma_f32_32x32x16_bf16 v[144:159], a[152:155], v[204:207], v[144:159]
    v_mfma_f32_32x32x16_bf16 v[208:223], a[156:159], v[204:207], v[208:223]
    s_waitcnt vmcnt(9)
    v_mfma_f32_32x32x16_bf16 v[144:159], a[160:163], v[96:99], v[144:159]
    v_mfma_f32_32x32x16_bf16 v[208:223], a[164:167], v[96:99], v[208:223]
    s_waitcnt vmcnt(8)
    v_mfma_f32_32x32x16_bf16 v[144:159], a[168:171], v[100:103], v[144:159]
    v_mfma_f32_32x32x16_bf16 v[208:223], a[172:175], v[100:103], v[208:223]
    s_waitcnt vmcnt(7)
    v_mfma_f32_32x32x16_bf16 v[144:159], a[176:179], v[104:107], v[144:159]
    v_mfma_f32_32x32x16_bf16 v[208:223], a[180:183], v[104:107], v[208:223]
    s_waitcnt vmcnt(6)
    v_mfma_f32_32x32x16_bf16 v[144:159], a[184:187], v[108:111], v[144:159]
    v_mfma_f32_32x32x16_bf16 v[208:223], a[188:191], v[108:111], v[208:223]
    s_waitcnt vmcnt(5)
    v_mfma_f32_32x32x16_bf16 v[144:159], a[192:195], v[112:115], v[144:159]
    v_mfma_f32_32x32x16_bf16 v[208:223], a[196:199], v[112:115], v[208:223]
    s_waitcnt vmcnt(4)
    v_mfma_f32_32x32x16_bf16 v[144:159], a[200:203], v[116:119], v[144:159]
    v_mfma_f32_32x32x16_bf16 v[208:223], a[204:207], v[116:119], v[208:223]
    s_waitcnt vmcnt(3)
    v_mfma_f32_32x32x16_bf16 v[144:159], a[208:211], v[120:123], v[144:159]
    v_mfma_f32_32x32x16_bf16 v[208:223], a[212:215], v[120:123], v[208:223]
    s_waitcnt vmcnt(2)
    v_mfma_f32_32x32x16_bf16 v[144:159], a[216:219], v[124:127], v[144:159]
    v_mfma_f32_32x32x16_bf16 v[208:223], a[220:223], v[124:127], v[208:223]
    s_nop 10
    ds_write_b128 v24, v[144:147] offset:32768
    ds_write_b128 v24, v[148:151] offset:33792
    ds_write_b128 v24, v[152:155] offset:34816
    ds_write_b128 v24, v[156:159] offset:35840
    ds_write_b128 v24, v[208:211] offset:36864
    ds_write_b128 v24, v[212:215] offset:37888
    ds_write_b128 v24, v[216:219] offset:38912
    ds_write_b128 v24, v[220:223] offset:39936
    s_waitcnt lgkmcnt(0)
    s_barrier
    ds_read_b128 v[96:99], v20 offset:32768
    ds_read_b128 v[112:115], v20 offset:33792
    ds_read_b128 v[100:103], v20 offset:40960
    ds_read_b128 v[116:119], v20 offset:41984
    ds_read_b128 v[104:107], v20 offset:49152
    ds_read_b128 v[120:123], v20 offset:50176
    ds_read_b128 v[108:111], v20 offset:57344
    ds_read_b128 v[124:127], v20 offset:58368
    v_lshlrev_b32 v80, 16, v72
    v_and_b32 v81, 0xffff0000, v72
    v_lshlrev_b32 v82, 16, v73
    v_and_b32 v83, 0xffff0000, v73
    v_lshlrev_b32 v84, 16, v74
    v_and_b32 v85, 0xffff0000, v74
    v_lshlrev_b32 v86, 16, v75
    v_and_b32 v87, 0xffff0000, v75
    s_waitcnt lgkmcnt(0)
    v_pk_add_f32 v[96:97], v[96:97], v[100:101]
    v_pk_add_f32 v[104:105], v[104:105], v[108:109]
    v_pk_add_f32 v[98:99], v[98:99], v[102:103]
    v_pk_add_f32 v[106:107], v[106:107], v[110:111]
    v_pk_add_f32 v[112:113], v[112:113], v[116:117]
    v_pk_add_f32 v[120:121], v[120:121], v[124:125]
    v_pk_add_f32 v[114:115], v[114:115], v[118:119]
    v_pk_add_f32 v[122:123], v[122:123], v[126:127]
    v_pk_add_f32 v[96:97], v[96:97], v[104:105]
    v_pk_add_f32 v[98:99], v[98:99], v[106:107]
    v_pk_add_f32 v[112:113], v[112:113], v[120:121]
    v_pk_add_f32 v[114:115], v[114:115], v[122:123]
    v_cvt_pk_bf16_f32 v224, v96, v97
    v_cvt_pk_bf16_f32 v225, v98, v99
    v_cvt_pk_bf16_f32 v226, v112, v113
    v_cvt_pk_bf16_f32 v227, v114, v115
    v_lshlrev_b32 v96, 16, v224
    v_and_b32 v97, 0xffff0000, v224
    v_lshlrev_b32 v98, 16, v225
    v_and_b32 v99, 0xffff0000, v225
    v_lshlrev_b32 v112, 16, v226
    v_and_b32 v113, 0xffff0000, v226
    v_lshlrev_b32 v114, 16, v227
    v_and_b32 v115, 0xffff0000, v227
    v_pk_add_f32 v[96:97], v[96:97], v[80:81]
    v_pk_add_f32 v[98:99], v[98:99], v[82:83]
    v_pk_add_f32 v[112:113], v[112:113], v[84:85]
    v_pk_add_f32 v[114:115], v[114:115], v[86:87]
    v_cvt_pk_bf16_f32 v228, v96, v97
    v_cvt_pk_bf16_f32 v229, v98, v99
    v_cvt_pk_bf16_f32 v230, v112, v113
    v_cvt_pk_bf16_f32 v231, v114, v115
    s_mov_b32 s63, 1792
    buffer_store_dwordx2 v[228:229], v22, s[48:51], s63 offen offset:0
    buffer_store_dwordx2 v[230:231], v22, s[48:51], s63 offen offset:16
K_END:
    s_endpgm

FA_RETRY:
    s_add_u32 s62, s55, 65536
    buffer_load_dword v32, v29, s[56:59], s62 offen sc0 sc1
    s_waitcnt vmcnt(0)
    s_branch FA_CHK
FB_RETRY:
    s_add_u32 s62, s55, 131072
    buffer_load_dword v33, v29, s[56:59], s62 offen sc0 sc1
    s_waitcnt vmcnt(0)
    s_branch FB_CHK
K_END2:
    s_endpgm
.section .rodata,"a"
.p2align 6
.amdhsa_kernel sequential_preLN__spectral_gfnet__glu_gated_glu__prompt_kernel
  .amdhsa_next_free_vgpr 512
  .amdhsa_next_free_sgpr 102
  .amdhsa_accum_offset 256
  .amdhsa_group_segment_fixed_size 0
  .amdhsa_kernarg_size 80
  .amdhsa_user_sgpr_count 2
  .amdhsa_user_sgpr_kernarg_segment_ptr 1
  .amdhsa_system_sgpr_workgroup_id_x 1
.end_amdhsa_kernel
```
